```python
import torch

def _softmax(x, axis=-1):
    return torch.softmax(x, dim=axis)
def _gelu(x):
    return torch.nn.functional.gelu(x, approximate="tanh")
def _silu(x):
    return torch.nn.functional.silu(x)
def _sigmoid(x):
    return torch.sigmoid(x)
def _layernorm(x, axis=-1, eps=1e-5):
    m = x.mean(dim=axis, keepdim=True)
    v = x.var(dim=axis, keepdim=True, unbiased=False)
    return (x - m) / torch.sqrt(v + eps)
def _scatter_add(tgt, idx, src, axis=0):
    return tgt.clone().index_add_(axis, idx, src)
def _segment_sum(src, seg, n):
    out = torch.zeros((n,) + src.shape[1:], dtype=src.dtype)
    return out.index_add_(0, seg, src)
def _pad(x, pw):
    flat = tuple(v for pair in reversed(pw) for v in pair)
    return torch.nn.functional.pad(x, flat)

kernel_name = 'gated_mix__softmax_full_mha__swiglu_ffn__prompt'

def setup_inputs():

    _w = (lambda a: (lambda t: t.to(torch.bfloat16) if t.is_floating_point() else t)(torch.as_tensor(a)))
    def _A_setup():
        B, S, D = 1, 2048, 1024
        return {
            "x": _w((lambda *s: torch.randn(*s, dtype=torch.bfloat16) * 0.05)(B, S, D)),
            "wqkv": _w((lambda *s: torch.randn(*s, dtype=torch.bfloat16) * 0.8)(D, 3 * D)),
            "wo": _w((lambda *s: torch.randn(*s, dtype=torch.bfloat16) * 0.05)(D, D)),
        }
    _A_in = _A_setup()

    def _B_setup():
        B, S, D, F = 1, 2048, 1024, 3584
        return {
            "x": _w((lambda *s: torch.randn(*s, dtype=torch.bfloat16) * 0.05)(B, S, D)),
            "w_gate": _w((lambda *s: torch.randn(*s, dtype=torch.bfloat16) * 0.1)(D, F)),
            "w_up": _w((lambda *s: torch.randn(*s, dtype=torch.bfloat16) * 0.1)(D, F)),
            "w_down": _w((lambda *s: torch.randn(*s, dtype=torch.bfloat16) * 0.1)(F, D)),
        }
    _B_in = _B_setup()

    return {
        "A_x": _A_in["x"],
        "A_wqkv": _A_in["wqkv"],
        "A_wo": _A_in["wo"],
        "B_x": _B_in["x"],
        "B_w_gate": _B_in["w_gate"],
        "B_w_up": _B_in["w_up"],
        "B_w_down": _B_in["w_down"],
        "gate_w": _w((lambda *s: torch.randn(*s, dtype=torch.bfloat16) * 0.05)(1024) * 16.0),
    }

def reference(A_x, A_wqkv, A_wo, B_x, B_w_gate, B_w_up, B_w_down, gate_w):
    def _A_ref(x, wqkv, wo):
        B, S, D = x.shape
        H = 32; Dh = D // H
        qkv = (lambda x, *d: x.permute(*d))((x @ wqkv).reshape(B, S, 3, H, Dh), 2, 0, 3, 1, 4)
        q, k, v = qkv[0], qkv[1], qkv[2]
        scale = Dh ** -0.5
        scores = torch.einsum("bhqd,bhkd->bhqk", q, k) * scale
        p = _softmax(scores, axis=-1)
        o = torch.einsum("bhqk,bhkd->bhqd", p, v)
        return (lambda x, *d: x.permute(*d))(o, 0, 2, 1, 3).reshape(B, S, D) @ wo

    def _B_ref(x, w_gate, w_up, w_down):
        g = _silu(x @ w_gate)
        u = x @ w_up
        return (g * u) @ w_down

    x = A_x
    g = _sigmoid((x * gate_w).sum(-1, keepdims=True))
    a = _A_ref(x, A_wqkv, A_wo)
    b = _B_ref(x, B_w_gate, B_w_up, B_w_down)
    return g * a + (1 - g) * b
```

```asm
; @launch grid=(256,1,1) block=(512,1,1) lds=163840
.amdgcn_target "amdgcn-amd-amdhsa--gfx950"
.text
.globl gated_mix__softmax_full_mha__swiglu_ffn__prompt_kernel
.p2align 8
.type gated_mix__softmax_full_mha__swiglu_ffn__prompt_kernel,@function
gated_mix__softmax_full_mha__swiglu_ffn__prompt_kernel:
    s_cmp_ge_u32 s2, 256
    s_cbranch_scc1 L_end
    s_load_dwordx2 s[12:13], s[0:1], 0
    s_load_dwordx2 s[16:17], s[0:1], 8
    s_load_dwordx2 s[20:21], s[0:1], 32
    s_load_dwordx2 s[24:25], s[0:1], 40
    s_load_dwordx2 s[4:5], s[0:1], 80
    s_load_dwordx2 s[8:9], s[0:1], 72
    s_load_dwordx2 s[64:65], s[0:1], 56
    v_and_b32 v228, 63, v0
    v_lshrrev_b32 v232, 6, v0
    v_lshlrev_b32 v229, 4, v228
    v_readfirstlane_b32 s3, v232
    s_getpc_b64 s[28:29]
L_p1_pc:
    s_sub_u32 s28, s28, L_p1_pc-gated_mix__softmax_full_mha__swiglu_ffn__prompt_kernel
    s_subb_u32 s29, s29, 0
    s_cmp_eq_u32 s3, 7
    s_cselect_b32 s30, L_code_end-gated_mix__softmax_full_mha__swiglu_ffn__prompt_kernel, 0
    s_mov_b32 s31, 0x00020000
    s_lshr_b32 s39, s2, 3
    s_and_b32 s39, s39, 3
    s_lshl_b32 s47, s39, 13
    v_lshlrev_b32 v233, 7, v228
    buffer_load_dword v227, v233, s[28:31], s47 offen
    s_and_b32 s38, s2, 7
    s_lshr_b32 s37, s2, 5
    s_lshl_b32 s36, s3, 10
    s_and_b32 s51, s3, 1
    s_lshl_b32 s47, s51, 2
    v_lshrrev_b32 v232, 4, v228
    v_add_u32 v232, s47, v232
    v_and_b32 v233, 7, v228
    v_xor_b32 v232, v232, v233
    v_lshlrev_b32 v232, 4, v232
    v_lshrrev_b32 v234, 3, v228
    s_lshl_b32 s47, s37, 8
    s_lshl_b32 s48, s3, 3
    s_add_u32 s47, s47, s48
    v_add_u32 v235, s47, v234
    v_lshlrev_b32 v235, 11, v235
    v_add_u32 v220, v235, v232
    v_add_u32 v221, 131072, v220
    v_add_u32 v222, 262144, v220
    v_add_u32 v223, 393216, v220
    v_and_b32 v232, 2, v234
    s_lshl_b32 s47, s51, 2
    v_or_b32 v232, s47, v232
    v_xor_b32 v232, v232, v233
    v_lshlrev_b32 v232, 4, v232
    v_add_u32 v235, s48, v234
    v_mul_u32_u24 v224, 6144, v235
    v_add_u32 v224, v224, v232
    v_mul_u32_u24 v225, 7168, v235
    v_add_u32 v225, v225, v232
    s_mov_b32 s40, 0
    s_mul_i32 s62, s38, 3
    s_add_u32 s62, s62, s39
    s_lshl_b32 s47, s62, 8
    s_lshl_b32 s48, s38, 7
    s_add_u32 s49, s48, 6144
    s_cmp_eq_u32 s39, 3
    s_cselect_b32 s41, s49, s47
    s_mov_b32 s42, s41
    s_add_u32 s47, s47, 128
    s_lshl_b32 s59, s38, 1
    s_and_b32 s49, s39, 1
    s_add_u32 s59, s59, s49
    s_lshr_b32 s49, s39, 1
    s_lshl_b32 s49, s49, 4
    s_add_u32 s59, s59, s49
    s_lshl_b32 s49, s59, 7
    s_lshl_b32 s48, s38, 8
    s_add_u32 s48, s48, 4096
    s_add_u32 s50, s48, 128
    s_cmp_eq_u32 s39, 3
    s_cselect_b32 s43, s49, s47
    s_cselect_b32 s44, s48, s47
    s_cselect_b32 s45, s50, s49
    s_lshl_b32 s59, s59, 1
    s_add_u32 s59, s59, s51
    s_and_b32 s47, s3, 1
    s_lshl_b32 s47, s47, 3
    s_add_u32 s47, s47, 32
    s_cmp_eq_u32 s39, 3
    s_cselect_b32 s48, 2, 4
    s_cmp_ge_u32 s3, s48
    s_cselect_b32 s47, 8, s47
    s_mov_b32 s50, 7168
    s_cselect_b32 s50, 6144, s50
    s_cmp_ge_u32 s3, 5
    s_cselect_b32 s47, 0, s47
    s_cselect_b32 s50, 2048, s50
    s_cmp_eq_u32 s3, 6
    s_cselect_b32 s47, 48, s47
    s_cmp_eq_u32 s3, 7
    s_cselect_b32 s47, 16, s47
    s_load_dwordx2 s[32:33], s[0:1], s47
    s_lshl_b32 s34, s50, 10
    s_lshl_b32 s100, s50, 6
    s_mov_b32 s63, 0
    s_cmp_eq_u32 s3, 0
    s_cselect_b32 s63, s41, s63
    s_cmp_eq_u32 s3, 1
    s_cselect_b32 s63, s42, s63
    s_cmp_eq_u32 s3, 2
    s_cselect_b32 s63, s43, s63
    s_cmp_eq_u32 s3, 3
    s_cselect_b32 s63, s44, s63
    s_cmp_eq_u32 s3, 4
    s_cselect_b32 s63, s45, s63
    s_cmp_eq_u32 s3, 5
    s_cselect_b32 s34, 4194304, s34
    s_cselect_b32 s100, 128, s100
    s_cmp_gt_u32 s3, 5
    s_cselect_b32 s34, 0, s34
    s_mov_b32 s35, 0x00020000
    s_lshl_b32 s47, s37, 3
    s_lshl_b32 s48, s37, 8
    s_lshl_b32 s49, s39, 6
    s_add_u32 s48, s48, s49
    s_cmp_lt_u32 s3, 5
    s_cselect_b32 s47, s47, s48
    s_cselect_b32 s48, 7, 63
    v_and_b32 v226, s48, v228
    v_add_u32 v226, s47, v226
    v_mul_lo_u32 v226, v226, s50
    s_mov_b32 s14, 4194304
    s_mov_b32 s15, 0x00020000
    s_mov_b32 s18, 6291456
    s_mov_b32 s19, 0x00020000
    s_mov_b32 s22, 7340032
    s_mov_b32 s23, 0x00020000
    s_mov_b32 s26, 7340032
    s_mov_b32 s27, 0x00020000
    s_mov_b32 s6, 31506432
    s_mov_b32 s7, 0x00020000
    s_mov_b32 s10, 256
    s_mov_b32 s11, 0x00020000
    s_waitcnt lgkmcnt(0)
    buffer_load_dword v227, v226, s[32:35], s63 offen
    s_add_u32 s63, s63, s100
    buffer_load_dword v227, v226, s[32:35], s63 offen
    s_add_u32 s63, s63, s100
    s_cmp_eq_u32 s39, 3
    s_cbranch_scc1 L_p1_O
L_p1_E:
    s_add_u32 m0, s36, 0
    s_nop 0
    buffer_load_dwordx4 v220, s[12:15], s40 offen lds
    s_add_u32 m0, s36, 8192
    s_nop 0
    buffer_load_dwordx4 v221, s[12:15], s40 offen lds
    s_add_u32 m0, s36, 16384
    s_nop 0
    buffer_load_dwordx4 v222, s[12:15], s40 offen lds
    s_add_u32 m0, s36, 24576
    s_nop 0
    buffer_load_dwordx4 v223, s[12:15], s40 offen lds
    s_add_u32 s40, s40, 128
    s_add_u32 m0, s36, 65536
    s_nop 0
    buffer_load_dwordx4 v225, s[20:23], s41 offen lds
    s_add_u32 s41, s41, 458752
    s_add_u32 m0, s36, 73728
    s_nop 0
    buffer_load_dwordx4 v225, s[24:27], s42 offen lds
    s_add_u32 s42, s42, 458752
    s_add_u32 m0, s36, 81920
    s_nop 0
    buffer_load_dwordx4 v225, s[20:23], s43 offen lds
    s_add_u32 s43, s43, 458752
    s_add_u32 m0, s36, 90112
    s_nop 0
    buffer_load_dwordx4 v225, s[24:27], s44 offen lds
    s_add_u32 s44, s44, 458752
    s_add_u32 m0, s36, 98304
    s_nop 0
    buffer_load_dwordx4 v224, s[16:19], s45 offen lds
    s_add_u32 s45, s45, 393216
    buffer_load_dword v227, v226, s[32:35], s63 offen
    s_add_u32 s63, s63, s100
    buffer_load_dword v227, v226, s[32:35], s63 offen
    s_add_u32 s63, s63, s100
    s_mov_b32 s28, s64
    s_mov_b32 s29, s65
    s_mov_b32 s30, 2048
    s_mov_b32 s31, 0x00020000
    s_cmp_eq_u32 s3, 6
    s_cselect_b32 s47, 14, 4
    s_lshl_b32 s47, s47, 11
    s_mul_i32 s48, s47, s2
    s_add_u32 s47, s47, s48
    v_and_b32 v232, 15, v228
    v_lshlrev_b32 v232, 7, v232
    s_cmp_gt_u32 s3, 5
    s_cselect_b32 s34, s47, s34
    s_cselect_b32 s63, s48, s63
    s_cselect_b32 s100, 2048, s100
    s_cselect_b64 vcc, -1, 0
    s_nop 1
    v_cndmask_b32 v226, v226, v232, vcc
    s_lshr_b32 s65, s2, 6
    s_add_u32 s65, s65, 1
    s_lshr_b32 s47, s3, 1
    s_lshl_b32 s47, s47, 13
    v_and_b32 v233, 15, v228
    v_lshlrev_b32 v233, 7, v233
    v_add_u32 v235, s47, v233
    v_lshrrev_b32 v233, 1, v228
    v_and_b32 v233, 7, v233
    v_lshrrev_b32 v236, 4, v228
    v_xor_b32 v233, v233, v236
    v_lshlrev_b32 v233, 4, v233
    v_add_u32 v212, v235, v233
    v_xor_b32 v213, 64, v212
    v_lshlrev_b32 v236, 10, v236
    v_lshrrev_b32 v233, 2, v228
    v_and_b32 v233, 3, v233
    v_lshlrev_b32 v235, 7, v233
    v_add_u32 v236, v236, v235
    v_lshlrev_b32 v233, 2, v228
    v_and_b32 v233, 0x60, v233
    v_add_u32 v236, v236, v233
    v_and_b32 v233, 3, v228
    v_lshlrev_b32 v233, 3, v233
    v_add_u32 v236, v236, v233
    s_lshl_b32 s47, s51, 14
    s_add_u32 s47, s47, 65536
    s_mov_b32 s48, 98304
    s_lshl_b32 s58, s62, 2
    s_lshl_b32 s49, s51, 1
    s_add_u32 s58, s58, s49
    v_xor_b32 v214, 0, v236
    v_add_u32 v214, s47, v214
    v_xor_b32 v215, 32, v236
    v_add_u32 v215, s47, v215
    v_xor_b32 v216, 64, v236
    v_add_u32 v216, s47, v216
    v_xor_b32 v217, 96, v236
    v_add_u32 v217, s47, v217
    s_lshl_b32 s49, s51, 6
    v_xor_b32 v218, s49, v236
    v_add_u32 v218, s48, v218
    v_xor_b32 v219, 32, v218
    v_lshrrev_b32 v233, 3, v228
    v_lshlrev_b32 v233, 8, v233
    v_and_b32 v234, 7, v228
    v_lshlrev_b32 v234, 4, v234
    v_add_u32 v230, v233, v234
    s_mov_b32 s52, 0xbfb8aa3b
    s_mov_b32 s53, 0xbfb8aa3b
    s_mov_b32 s54, 1.0
    s_mov_b32 s55, 1.0
    s_lshl_b32 s47, s2, 3
    s_add_u32 s61, s47, s3
    v_mov_b64 v[0:1], 0
    v_mov_b64 v[2:3], 0
    v_mov_b64 v[4:5], 0
    v_mov_b64 v[6:7], 0
    v_mov_b64 v[8:9], 0
    v_mov_b64 v[10:11], 0
    v_mov_b64 v[12:13], 0
    v_mov_b64 v[14:15], 0
    v_mov_b64 v[16:17], 0
    v_mov_b64 v[18:19], 0
    v_mov_b64 v[20:21], 0
    v_mov_b64 v[22:23], 0
    v_mov_b64 v[24:25], 0
    v_mov_b64 v[26:27], 0
    v_mov_b64 v[28:29], 0
    v_mov_b64 v[30:31], 0
    v_mov_b64 v[32:33], 0
    v_mov_b64 v[34:35], 0
    v_mov_b64 v[36:37], 0
    v_mov_b64 v[38:39], 0
    v_mov_b64 v[40:41], 0
    v_mov_b64 v[42:43], 0
    v_mov_b64 v[44:45], 0
    v_mov_b64 v[46:47], 0
    v_mov_b64 v[48:49], 0
    v_mov_b64 v[50:51], 0
    v_mov_b64 v[52:53], 0
    v_mov_b64 v[54:55], 0
    v_mov_b64 v[56:57], 0
    v_mov_b64 v[58:59], 0
    v_mov_b64 v[60:61], 0
    v_mov_b64 v[62:63], 0
    v_mov_b64 v[64:65], 0
    v_mov_b64 v[66:67], 0
    v_mov_b64 v[68:69], 0
    v_mov_b64 v[70:71], 0
    v_mov_b64 v[72:73], 0
    v_mov_b64 v[74:75], 0
    v_mov_b64 v[76:77], 0
    v_mov_b64 v[78:79], 0
    v_mov_b64 v[80:81], 0
    v_mov_b64 v[82:83], 0
    v_mov_b64 v[84:85], 0
    v_mov_b64 v[86:87], 0
    v_mov_b64 v[88:89], 0
    v_mov_b64 v[90:91], 0
    v_mov_b64 v[92:93], 0
    v_mov_b64 v[94:95], 0
    v_mov_b64 v[96:97], 0
    v_mov_b64 v[98:99], 0
    v_mov_b64 v[100:101], 0
    v_mov_b64 v[102:103], 0
    v_mov_b64 v[104:105], 0
    v_mov_b64 v[106:107], 0
    v_mov_b64 v[108:109], 0
    v_mov_b64 v[110:111], 0
    v_mov_b64 v[112:113], 0
    v_mov_b64 v[114:115], 0
    v_mov_b64 v[116:117], 0
    v_mov_b64 v[118:119], 0
    v_mov_b64 v[120:121], 0
    v_mov_b64 v[122:123], 0
    v_mov_b64 v[124:125], 0
    v_mov_b64 v[126:127], 0
    v_mov_b64 v[128:129], 0
    v_mov_b64 v[130:131], 0
    v_mov_b64 v[132:133], 0
    v_mov_b64 v[134:135], 0
    v_mov_b64 v[136:137], 0
    v_mov_b64 v[138:139], 0
    v_mov_b64 v[140:141], 0
    v_mov_b64 v[142:143], 0
    v_mov_b64 v[144:145], 0
    v_mov_b64 v[146:147], 0
    v_mov_b64 v[148:149], 0
    v_mov_b64 v[150:151], 0
    v_mov_b64 v[152:153], 0
    v_mov_b64 v[154:155], 0
    v_mov_b64 v[156:157], 0
    v_mov_b64 v[158:159], 0
    v_lshlrev_b32 v233, 2, v228
    v_add_u32 v233, 147456, v233
    v_mov_b32 v232, 0
    ds_write_b32 v233, v232
    s_waitcnt lgkmcnt(0)
    s_lshl_b32 s47, s2, 7
    s_add_u32 s47, s47, 31473664
    v_mov_b32 v232, 0
    buffer_store_dword v232, v232, s[4:7], s47 offen sc1
    s_waitcnt vmcnt(3)
    s_barrier
    ds_read_b128 v[160:163], v212 offset:0
    ds_read_b128 v[164:167], v212 offset:2048
    ds_read_b128 v[168:171], v212 offset:4096
    ds_read_b128 v[172:175], v212 offset:6144
    ds_read_b64_tr_b16 v[192:193], v218 offset:0
    ds_read_b64_tr_b16 v[194:195], v218 offset:512
    ds_read_b64_tr_b16 v[196:197], v219 offset:0
    ds_read_b64_tr_b16 v[198:199], v219 offset:512
    ds_read_b64_tr_b16 v[200:201], v214 offset:0
    ds_read_b64_tr_b16 v[202:203], v214 offset:512
    ds_read_b64_tr_b16 v[204:205], v215 offset:0
    ds_read_b64_tr_b16 v[206:207], v215 offset:512
    s_add_u32 m0, s36, 32768
    s_nop 0
    buffer_load_dwordx4 v220, s[12:15], s40 offen lds
    s_add_u32 m0, s36, 40960
    s_nop 0
    buffer_load_dwordx4 v221, s[12:15], s40 offen lds
    s_mov_b32 s46, 0
.p2align 6
L_p1_E_loop:
    s_waitcnt lgkmcnt(4)
    v_mfma_f32_16x16x32_bf16 v[0:3], v[192:195], v[160:163], v[0:3]
    ds_read_b64_tr_b16 v[208:209], v214 offset:8192
    v_mfma_f32_16x16x32_bf16 v[4:7], v[192:195], v[164:167], v[4:7]
    ds_read_b64_tr_b16 v[210:211], v214 offset:8704
    v_mfma_f32_16x16x32_bf16 v[8:11], v[192:195], v[168:171], v[8:11]
    v_mfma_f32_16x16x32_bf16 v[12:15], v[192:195], v[172:175], v[12:15]
    s_add_u32 m0, s36, 49152
    s_nop 0
    buffer_load_dwordx4 v222, s[12:15], s40 offen lds
    v_mfma_f32_16x16x32_bf16 v[16:19], v[196:199], v[160:163], v[16:19]
    ds_read_b64_tr_b16 v[192:193], v215 offset:8192
    v_mfma_f32_16x16x32_bf16 v[20:23], v[196:199], v[164:167], v[20:23]
    ds_read_b64_tr_b16 v[194:195], v215 offset:8704
    v_mfma_f32_16x16x32_bf16 v[24:27], v[196:199], v[168:171], v[24:27]
    v_mfma_f32_16x16x32_bf16 v[28:31], v[196:199], v[172:175], v[28:31]
    s_add_u32 m0, s36, 57344
    s_nop 0
    buffer_load_dwordx4 v223, s[12:15], s40 offen lds
    s_add_u32 s40, s40, 128
    s_waitcnt lgkmcnt(4)
    v_mfma_f32_16x16x32_bf16 v[32:35], v[200:203], v[160:163], v[32:35]
    ds_read_b64_tr_b16 v[196:197], v216 offset:0
    v_mfma_f32_16x16x32_bf16 v[36:39], v[200:203], v[164:167], v[36:39]
    ds_read_b64_tr_b16 v[198:199], v216 offset:512
    v_mfma_f32_16x16x32_bf16 v[40:43], v[200:203], v[168:171], v[40:43]
    ds_read_b128 v[176:179], v213 offset:0
    v_mfma_f32_16x16x32_bf16 v[44:47], v[200:203], v[172:175], v[44:47]
    s_add_u32 m0, s36, 106496
    s_nop 0
    buffer_load_dwordx4 v225, s[20:23], s41 offen lds
    s_add_u32 s41, s41, 458752
    v_mfma_f32_16x16x32_bf16 v[48:51], v[204:207], v[160:163], v[48:51]
    ds_read_b64_tr_b16 v[200:201], v217 offset:0
    v_mfma_f32_16x16x32_bf16 v[52:55], v[204:207], v[164:167], v[52:55]
    ds_read_b64_tr_b16 v[202:203], v217 offset:512
    v_mfma_f32_16x16x32_bf16 v[56:59], v[204:207], v[168:171], v[56:59]
    ds_read_b128 v[180:183], v213 offset:2048
    v_mfma_f32_16x16x32_bf16 v[60:63], v[204:207], v[172:175], v[60:63]
    s_add_u32 m0, s36, 114688
    s_nop 0
    buffer_load_dwordx4 v225, s[24:27], s42 offen lds
    s_add_u32 s42, s42, 458752
    s_waitcnt lgkmcnt(4)
    v_mfma_f32_16x16x32_bf16 v[64:67], v[208:211], v[160:163], v[64:67]
    ds_read_b64_tr_b16 v[204:205], v216 offset:8192
    v_mfma_f32_16x16x32_bf16 v[68:71], v[208:211], v[164:167], v[68:71]
    ds_read_b64_tr_b16 v[206:207], v216 offset:8704
    v_mfma_f32_16x16x32_bf16 v[72:75], v[208:211], v[168:171], v[72:75]
    ds_read_b128 v[184:187], v213 offset:4096
    v_mfma_f32_16x16x32_bf16 v[76:79], v[208:211], v[172:175], v[76:79]
    s_add_u32 m0, s36, 122880
    s_nop 0
    buffer_load_dwordx4 v225, s[20:23], s43 offen lds
    s_add_u32 s43, s43, 458752
    v_mfma_f32_16x16x32_bf16 v[80:83], v[192:195], v[160:163], v[80:83]
    ds_read_b64_tr_b16 v[208:209], v217 offset:8192
    v_mfma_f32_16x16x32_bf16 v[84:87], v[192:195], v[164:167], v[84:87]
    ds_read_b64_tr_b16 v[210:211], v217 offset:8704
    v_mfma_f32_16x16x32_bf16 v[88:91], v[192:195], v[168:171], v[88:91]
    ds_read_b128 v[188:191], v213 offset:6144
    v_mfma_f32_16x16x32_bf16 v[92:95], v[192:195], v[172:175], v[92:95]
    s_add_u32 m0, s36, 131072
    s_nop 0
    buffer_load_dwordx4 v225, s[24:27], s44 offen lds
    s_add_u32 s44, s44, 458752
    s_waitcnt lgkmcnt(4)
    v_mfma_f32_16x16x32_bf16 v[96:99], v[196:199], v[160:163], v[96:99]
    ds_read_b64_tr_b16 v[192:193], v218 offset:4096
    v_mfma_f32_16x16x32_bf16 v[100:103], v[196:199], v[164:167], v[100:103]
    ds_read_b64_tr_b16 v[194:195], v218 offset:4608
    v_mfma_f32_16x16x32_bf16 v[104:107], v[196:199], v[168:171], v[104:107]
    v_mfma_f32_16x16x32_bf16 v[108:111], v[196:199], v[172:175], v[108:111]
    s_add_u32 m0, s36, 139264
    s_nop 0
    buffer_load_dwordx4 v224, s[16:19], s45 offen lds
    s_add_u32 s45, s45, 393216
    v_mfma_f32_16x16x32_bf16 v[112:115], v[200:203], v[160:163], v[112:115]
    ds_read_b64_tr_b16 v[196:197], v219 offset:4096
    v_mfma_f32_16x16x32_bf16 v[116:119], v[200:203], v[164:167], v[116:119]
    ds_read_b64_tr_b16 v[198:199], v219 offset:4608
    v_mfma_f32_16x16x32_bf16 v[120:123], v[200:203], v[168:171], v[120:123]
    v_mfma_f32_16x16x32_bf16 v[124:127], v[200:203], v[172:175], v[124:127]
    buffer_load_dword v227, v226, s[32:35], s63 offen
    s_add_u32 s63, s63, s100
    s_waitcnt lgkmcnt(4)
    v_mfma_f32_16x16x32_bf16 v[128:131], v[204:207], v[160:163], v[128:131]
    ds_read_b64_tr_b16 v[200:201], v214 offset:4096
    v_mfma_f32_16x16x32_bf16 v[132:135], v[204:207], v[164:167], v[132:135]
    ds_read_b64_tr_b16 v[202:203], v214 offset:4608
    v_mfma_f32_16x16x32_bf16 v[136:139], v[204:207], v[168:171], v[136:139]
    v_mfma_f32_16x16x32_bf16 v[140:143], v[204:207], v[172:175], v[140:143]
    v_mfma_f32_16x16x32_bf16 v[144:147], v[208:211], v[160:163], v[144:147]
    ds_read_b64_tr_b16 v[204:205], v215 offset:4096
    v_mfma_f32_16x16x32_bf16 v[148:151], v[208:211], v[164:167], v[148:151]
    ds_read_b64_tr_b16 v[206:207], v215 offset:4608
    v_mfma_f32_16x16x32_bf16 v[152:155], v[208:211], v[168:171], v[152:155]
    v_mfma_f32_16x16x32_bf16 v[156:159], v[208:211], v[172:175], v[156:159]
    s_waitcnt lgkmcnt(4)
    v_mfma_f32_16x16x32_bf16 v[0:3], v[192:195], v[176:179], v[0:3]
    ds_read_b64_tr_b16 v[208:209], v214 offset:12288
    v_mfma_f32_16x16x32_bf16 v[4:7], v[192:195], v[180:183], v[4:7]
    ds_read_b64_tr_b16 v[210:211], v214 offset:12800
    v_mfma_f32_16x16x32_bf16 v[8:11], v[192:195], v[184:187], v[8:11]
    v_mfma_f32_16x16x32_bf16 v[12:15], v[192:195], v[188:191], v[12:15]
    v_mfma_f32_16x16x32_bf16 v[16:19], v[196:199], v[176:179], v[16:19]
    ds_read_b64_tr_b16 v[192:193], v215 offset:12288
    v_mfma_f32_16x16x32_bf16 v[20:23], v[196:199], v[180:183], v[20:23]
    ds_read_b64_tr_b16 v[194:195], v215 offset:12800
    v_mfma_f32_16x16x32_bf16 v[24:27], v[196:199], v[184:187], v[24:27]
    v_mfma_f32_16x16x32_bf16 v[28:31], v[196:199], v[188:191], v[28:31]
    s_waitcnt lgkmcnt(4)
    v_mfma_f32_16x16x32_bf16 v[32:35], v[200:203], v[176:179], v[32:35]
    ds_read_b64_tr_b16 v[196:197], v216 offset:4096
    v_mfma_f32_16x16x32_bf16 v[36:39], v[200:203], v[180:183], v[36:39]
    ds_read_b64_tr_b16 v[198:199], v216 offset:4608
    v_mfma_f32_16x16x32_bf16 v[40:43], v[200:203], v[184:187], v[40:43]
    v_mfma_f32_16x16x32_bf16 v[44:47], v[200:203], v[188:191], v[44:47]
    v_mfma_f32_16x16x32_bf16 v[48:51], v[204:207], v[176:179], v[48:51]
    ds_read_b64_tr_b16 v[200:201], v217 offset:4096
    v_mfma_f32_16x16x32_bf16 v[52:55], v[204:207], v[180:183], v[52:55]
    ds_read_b64_tr_b16 v[202:203], v217 offset:4608
    v_mfma_f32_16x16x32_bf16 v[56:59], v[204:207], v[184:187], v[56:59]
    v_mfma_f32_16x16x32_bf16 v[60:63], v[204:207], v[188:191], v[60:63]
    s_waitcnt lgkmcnt(4)
    v_mfma_f32_16x16x32_bf16 v[64:67], v[208:211], v[176:179], v[64:67]
    ds_read_b64_tr_b16 v[204:205], v216 offset:12288
    v_mfma_f32_16x16x32_bf16 v[68:71], v[208:211], v[180:183], v[68:71]
    ds_read_b64_tr_b16 v[206:207], v216 offset:12800
    v_mfma_f32_16x16x32_bf16 v[72:75], v[208:211], v[184:187], v[72:75]
    v_mfma_f32_16x16x32_bf16 v[76:79], v[208:211], v[188:191], v[76:79]
    v_mfma_f32_16x16x32_bf16 v[80:83], v[192:195], v[176:179], v[80:83]
    ds_read_b64_tr_b16 v[208:209], v217 offset:12288
    v_mfma_f32_16x16x32_bf16 v[84:87], v[192:195], v[180:183], v[84:87]
    ds_read_b64_tr_b16 v[210:211], v217 offset:12800
    v_mfma_f32_16x16x32_bf16 v[88:91], v[192:195], v[184:187], v[88:91]
    v_mfma_f32_16x16x32_bf16 v[92:95], v[192:195], v[188:191], v[92:95]
    s_waitcnt vmcnt(1) lgkmcnt(0)
    s_barrier
    s_cmp_eq_u32 s46, s65
    s_cbranch_scc0 L_p1_E_e0
    s_cmp_lg_u32 s3, 0
    s_cbranch_scc1 L_p1_E_e0
    v_mov_b32 v248, 1
    v_mov_b32 v249, 0
    s_mov_b64 exec, 1
    buffer_atomic_add v248, v249, s[8:11], 0 offen sc1
    s_mov_b64 exec, -1
L_p1_E_e0:
    s_cmp_eq_u32 s46, 7
    s_cbranch_scc0 L_p1_E_e7
    v_mov_b32 v249, 0
    buffer_load_dword v251, v249, s[8:11], 0 offen sc1
    s_lshl_b32 s47, s61, 11
    v_lshlrev_b32 v248, 5, v228
    buffer_load_dwordx4 v[232:235], v248, s[12:15], s47 offen
    buffer_load_dwordx4 v[236:239], v248, s[12:15], s47 offen offset:16
    buffer_load_dwordx4 v[240:243], v248, s[28:31], 0 offen
    buffer_load_dwordx4 v[244:247], v248, s[28:31], 0 offen offset:16
    s_mov_b32 s14, 0
    s_mov_b32 s18, 0
    s_mov_b32 s22, 0
    s_mov_b32 s26, 0
    s_mov_b32 s34, 0
L_p1_E_e7:
    v_mfma_f32_16x16x32_bf16 v[96:99], v[196:199], v[176:179], v[96:99]
    ds_read_b64_tr_b16 v[192:193], v218 offset:40960
    v_mfma_f32_16x16x32_bf16 v[100:103], v[196:199], v[180:183], v[100:103]
    ds_read_b64_tr_b16 v[194:195], v218 offset:41472
    v_mfma_f32_16x16x32_bf16 v[104:107], v[196:199], v[184:187], v[104:107]
    ds_read_b128 v[160:163], v212 offset:32768
    v_mfma_f32_16x16x32_bf16 v[108:111], v[196:199], v[188:191], v[108:111]
    ds_read_b128 v[164:167], v212 offset:34816
    v_mfma_f32_16x16x32_bf16 v[112:115], v[200:203], v[176:179], v[112:115]
    ds_read_b64_tr_b16 v[196:197], v219 offset:40960
    v_mfma_f32_16x16x32_bf16 v[116:119], v[200:203], v[180:183], v[116:119]
    ds_read_b64_tr_b16 v[198:199], v219 offset:41472
    v_mfma_f32_16x16x32_bf16 v[120:123], v[200:203], v[184:187], v[120:123]
    ds_read_b128 v[168:171], v212 offset:36864
    v_mfma_f32_16x16x32_bf16 v[124:127], v[200:203], v[188:191], v[124:127]
    ds_read_b128 v[172:175], v212 offset:38912
    v_mfma_f32_16x16x32_bf16 v[128:131], v[204:207], v[176:179], v[128:131]
    ds_read_b64_tr_b16 v[200:201], v214 offset:40960
    v_mfma_f32_16x16x32_bf16 v[132:135], v[204:207], v[180:183], v[132:135]
    ds_read_b64_tr_b16 v[202:203], v214 offset:41472
    v_mfma_f32_16x16x32_bf16 v[136:139], v[204:207], v[184:187], v[136:139]
    v_mfma_f32_16x16x32_bf16 v[140:143], v[204:207], v[188:191], v[140:143]
    s_add_u32 m0, s36, 0
    s_nop 0
    buffer_load_dwordx4 v220, s[12:15], s40 offen lds
    v_mfma_f32_16x16x32_bf16 v[144:147], v[208:211], v[176:179], v[144:147]
    ds_read_b64_tr_b16 v[204:205], v215 offset:40960
    v_mfma_f32_16x16x32_bf16 v[148:151], v[208:211], v[180:183], v[148:151]
    ds_read_b64_tr_b16 v[206:207], v215 offset:41472
    v_mfma_f32_16x16x32_bf16 v[152:155], v[208:211], v[184:187], v[152:155]
    v_mfma_f32_16x16x32_bf16 v[156:159], v[208:211], v[188:191], v[156:159]
    s_add_u32 m0, s36, 8192
    s_nop 0
    buffer_load_dwordx4 v221, s[12:15], s40 offen lds
    s_cmp_eq_u32 s46, 7
    s_cbranch_scc1 L_p1_E_last
    s_waitcnt lgkmcnt(4)
    v_mfma_f32_16x16x32_bf16 v[0:3], v[192:195], v[160:163], v[0:3]
    ds_read_b64_tr_b16 v[208:209], v214 offset:49152
    v_mfma_f32_16x16x32_bf16 v[4:7], v[192:195], v[164:167], v[4:7]
    ds_read_b64_tr_b16 v[210:211], v214 offset:49664
    v_mfma_f32_16x16x32_bf16 v[8:11], v[192:195], v[168:171], v[8:11]
    v_mfma_f32_16x16x32_bf16 v[12:15], v[192:195], v[172:175], v[12:15]
    s_add_u32 m0, s36, 16384
    s_nop 0
    buffer_load_dwordx4 v222, s[12:15], s40 offen lds
    v_mfma_f32_16x16x32_bf16 v[16:19], v[196:199], v[160:163], v[16:19]
    ds_read_b64_tr_b16 v[192:193], v215 offset:49152
    v_mfma_f32_16x16x32_bf16 v[20:23], v[196:199], v[164:167], v[20:23]
    ds_read_b64_tr_b16 v[194:195], v215 offset:49664
    v_mfma_f32_16x16x32_bf16 v[24:27], v[196:199], v[168:171], v[24:27]
    v_mfma_f32_16x16x32_bf16 v[28:31], v[196:199], v[172:175], v[28:31]
    s_add_u32 m0, s36, 24576
    s_nop 0
    buffer_load_dwordx4 v223, s[12:15], s40 offen lds
    s_add_u32 s40, s40, 128
    s_waitcnt lgkmcnt(4)
    v_mfma_f32_16x16x32_bf16 v[32:35], v[200:203], v[160:163], v[32:35]
    ds_read_b64_tr_b16 v[196:197], v216 offset:40960
    v_mfma_f32_16x16x32_bf16 v[36:39], v[200:203], v[164:167], v[36:39]
    ds_read_b64_tr_b16 v[198:199], v216 offset:41472
    v_mfma_f32_16x16x32_bf16 v[40:43], v[200:203], v[168:171], v[40:43]
    ds_read_b128 v[176:179], v213 offset:32768
    v_mfma_f32_16x16x32_bf16 v[44:47], v[200:203], v[172:175], v[44:47]
    s_add_u32 m0, s36, 65536
    s_nop 0
    buffer_load_dwordx4 v225, s[20:23], s41 offen lds
    s_add_u32 s41, s41, 458752
    v_mfma_f32_16x16x32_bf16 v[48:51], v[204:207], v[160:163], v[48:51]
    ds_read_b64_tr_b16 v[200:201], v217 offset:40960
    v_mfma_f32_16x16x32_bf16 v[52:55], v[204:207], v[164:167], v[52:55]
    ds_read_b64_tr_b16 v[202:203], v217 offset:41472
    v_mfma_f32_16x16x32_bf16 v[56:59], v[204:207], v[168:171], v[56:59]
    ds_read_b128 v[180:183], v213 offset:34816
    v_mfma_f32_16x16x32_bf16 v[60:63], v[204:207], v[172:175], v[60:63]
    s_add_u32 m0, s36, 73728
    s_nop 0
    buffer_load_dwordx4 v225, s[24:27], s42 offen lds
    s_add_u32 s42, s42, 458752
    s_waitcnt lgkmcnt(4)
    v_mfma_f32_16x16x32_bf16 v[64:67], v[208:211], v[160:163], v[64:67]
    ds_read_b64_tr_b16 v[204:205], v216 offset:49152
    v_mfma_f32_16x16x32_bf16 v[68:71], v[208:211], v[164:167], v[68:71]
    ds_read_b64_tr_b16 v[206:207], v216 offset:49664
    v_mfma_f32_16x16x32_bf16 v[72:75], v[208:211], v[168:171], v[72:75]
    ds_read_b128 v[184:187], v213 offset:36864
    v_mfma_f32_16x16x32_bf16 v[76:79], v[208:211], v[172:175], v[76:79]
    s_add_u32 m0, s36, 81920
    s_nop 0
    buffer_load_dwordx4 v225, s[20:23], s43 offen lds
    s_add_u32 s43, s43, 458752
    v_mfma_f32_16x16x32_bf16 v[80:83], v[192:195], v[160:163], v[80:83]
    ds_read_b64_tr_b16 v[208:209], v217 offset:49152
    v_mfma_f32_16x16x32_bf16 v[84:87], v[192:195], v[164:167], v[84:87]
    ds_read_b64_tr_b16 v[210:211], v217 offset:49664
    v_mfma_f32_16x16x32_bf16 v[88:91], v[192:195], v[168:171], v[88:91]
    ds_read_b128 v[188:191], v213 offset:38912
    v_mfma_f32_16x16x32_bf16 v[92:95], v[192:195], v[172:175], v[92:95]
    s_add_u32 m0, s36, 90112
    s_nop 0
    buffer_load_dwordx4 v225, s[24:27], s44 offen lds
    s_add_u32 s44, s44, 458752
    s_waitcnt lgkmcnt(4)
    v_mfma_f32_16x16x32_bf16 v[96:99], v[196:199], v[160:163], v[96:99]
    ds_read_b64_tr_b16 v[192:193], v218 offset:45056
    v_mfma_f32_16x16x32_bf16 v[100:103], v[196:199], v[164:167], v[100:103]
    ds_read_b64_tr_b16 v[194:195], v218 offset:45568
    v_mfma_f32_16x16x32_bf16 v[104:107], v[196:199], v[168:171], v[104:107]
    v_mfma_f32_16x16x32_bf16 v[108:111], v[196:199], v[172:175], v[108:111]
    s_add_u32 m0, s36, 98304
    s_nop 0
    buffer_load_dwordx4 v224, s[16:19], s45 offen lds
    s_add_u32 s45, s45, 393216
    v_mfma_f32_16x16x32_bf16 v[112:115], v[200:203], v[160:163], v[112:115]
    ds_read_b64_tr_b16 v[196:197], v219 offset:45056
    v_mfma_f32_16x16x32_bf16 v[116:119], v[200:203], v[164:167], v[116:119]
    ds_read_b64_tr_b16 v[198:199], v219 offset:45568
    v_mfma_f32_16x16x32_bf16 v[120:123], v[200:203], v[168:171], v[120:123]
    v_mfma_f32_16x16x32_bf16 v[124:127], v[200:203], v[172:175], v[124:127]
    buffer_load_dword v227, v226, s[32:35], s63 offen
    s_add_u32 s63, s63, s100
    s_waitcnt lgkmcnt(4)
    v_mfma_f32_16x16x32_bf16 v[128:131], v[204:207], v[160:163], v[128:131]
    ds_read_b64_tr_b16 v[200:201], v214 offset:45056
    v_mfma_f32_16x16x32_bf16 v[132:135], v[204:207], v[164:167], v[132:135]
    ds_read_b64_tr_b16 v[202:203], v214 offset:45568
    v_mfma_f32_16x16x32_bf16 v[136:139], v[204:207], v[168:171], v[136:139]
    v_mfma_f32_16x16x32_bf16 v[140:143], v[204:207], v[172:175], v[140:143]
    v_mfma_f32_16x16x32_bf16 v[144:147], v[208:211], v[160:163], v[144:147]
    ds_read_b64_tr_b16 v[204:205], v215 offset:45056
    v_mfma_f32_16x16x32_bf16 v[148:151], v[208:211], v[164:167], v[148:151]
    ds_read_b64_tr_b16 v[206:207], v215 offset:45568
    v_mfma_f32_16x16x32_bf16 v[152:155], v[208:211], v[168:171], v[152:155]
    v_mfma_f32_16x16x32_bf16 v[156:159], v[208:211], v[172:175], v[156:159]
    s_waitcnt lgkmcnt(4)
    v_mfma_f32_16x16x32_bf16 v[0:3], v[192:195], v[176:179], v[0:3]
    ds_read_b64_tr_b16 v[208:209], v214 offset:53248
    v_mfma_f32_16x16x32_bf16 v[4:7], v[192:195], v[180:183], v[4:7]
    ds_read_b64_tr_b16 v[210:211], v214 offset:53760
    v_mfma_f32_16x16x32_bf16 v[8:11], v[192:195], v[184:187], v[8:11]
    v_mfma_f32_16x16x32_bf16 v[12:15], v[192:195], v[188:191], v[12:15]
    v_mfma_f32_16x16x32_bf16 v[16:19], v[196:199], v[176:179], v[16:19]
    ds_read_b64_tr_b16 v[192:193], v215 offset:53248
    v_mfma_f32_16x16x32_bf16 v[20:23], v[196:199], v[180:183], v[20:23]
    ds_read_b64_tr_b16 v[194:195], v215 offset:53760
    v_mfma_f32_16x16x32_bf16 v[24:27], v[196:199], v[184:187], v[24:27]
    v_mfma_f32_16x16x32_bf16 v[28:31], v[196:199], v[188:191], v[28:31]
    s_waitcnt lgkmcnt(4)
    v_mfma_f32_16x16x32_bf16 v[32:35], v[200:203], v[176:179], v[32:35]
    ds_read_b64_tr_b16 v[196:197], v216 offset:45056
    v_mfma_f32_16x16x32_bf16 v[36:39], v[200:203], v[180:183], v[36:39]
    ds_read_b64_tr_b16 v[198:199], v216 offset:45568
    v_mfma_f32_16x16x32_bf16 v[40:43], v[200:203], v[184:187], v[40:43]
    v_mfma_f32_16x16x32_bf16 v[44:47], v[200:203], v[188:191], v[44:47]
    v_mfma_f32_16x16x32_bf16 v[48:51], v[204:207], v[176:179], v[48:51]
    ds_read_b64_tr_b16 v[200:201], v217 offset:45056
    v_mfma_f32_16x16x32_bf16 v[52:55], v[204:207], v[180:183], v[52:55]
    ds_read_b64_tr_b16 v[202:203], v217 offset:45568
    v_mfma_f32_16x16x32_bf16 v[56:59], v[204:207], v[184:187], v[56:59]
    v_mfma_f32_16x16x32_bf16 v[60:63], v[204:207], v[188:191], v[60:63]
    s_waitcnt lgkmcnt(4)
    v_mfma_f32_16x16x32_bf16 v[64:67], v[208:211], v[176:179], v[64:67]
    ds_read_b64_tr_b16 v[204:205], v216 offset:53248
    v_mfma_f32_16x16x32_bf16 v[68:71], v[208:211], v[180:183], v[68:71]
    ds_read_b64_tr_b16 v[206:207], v216 offset:53760
    v_mfma_f32_16x16x32_bf16 v[72:75], v[208:211], v[184:187], v[72:75]
    v_mfma_f32_16x16x32_bf16 v[76:79], v[208:211], v[188:191], v[76:79]
    v_mfma_f32_16x16x32_bf16 v[80:83], v[192:195], v[176:179], v[80:83]
    ds_read_b64_tr_b16 v[208:209], v217 offset:53248
    v_mfma_f32_16x16x32_bf16 v[84:87], v[192:195], v[180:183], v[84:87]
    ds_read_b64_tr_b16 v[210:211], v217 offset:53760
    v_mfma_f32_16x16x32_bf16 v[88:91], v[192:195], v[184:187], v[88:91]
    v_mfma_f32_16x16x32_bf16 v[92:95], v[192:195], v[188:191], v[92:95]
    s_waitcnt vmcnt(1) lgkmcnt(0)
    s_barrier
    v_mfma_f32_16x16x32_bf16 v[96:99], v[196:199], v[176:179], v[96:99]
    ds_read_b64_tr_b16 v[192:193], v218 offset:0
    v_mfma_f32_16x16x32_bf16 v[100:103], v[196:199], v[180:183], v[100:103]
    ds_read_b64_tr_b16 v[194:195], v218 offset:512
    v_mfma_f32_16x16x32_bf16 v[104:107], v[196:199], v[184:187], v[104:107]
    ds_read_b128 v[160:163], v212 offset:0
    v_mfma_f32_16x16x32_bf16 v[108:111], v[196:199], v[188:191], v[108:111]
    ds_read_b128 v[164:167], v212 offset:2048
    v_mfma_f32_16x16x32_bf16 v[112:115], v[200:203], v[176:179], v[112:115]
    ds_read_b64_tr_b16 v[196:197], v219 offset:0
    v_mfma_f32_16x16x32_bf16 v[116:119], v[200:203], v[180:183], v[116:119]
    ds_read_b64_tr_b16 v[198:199], v219 offset:512
    v_mfma_f32_16x16x32_bf16 v[120:123], v[200:203], v[184:187], v[120:123]
    ds_read_b128 v[168:171], v212 offset:4096
    v_mfma_f32_16x16x32_bf16 v[124:127], v[200:203], v[188:191], v[124:127]
    ds_read_b128 v[172:175], v212 offset:6144
    v_mfma_f32_16x16x32_bf16 v[128:131], v[204:207], v[176:179], v[128:131]
    ds_read_b64_tr_b16 v[200:201], v214 offset:0
    v_mfma_f32_16x16x32_bf16 v[132:135], v[204:207], v[180:183], v[132:135]
    ds_read_b64_tr_b16 v[202:203], v214 offset:512
    v_mfma_f32_16x16x32_bf16 v[136:139], v[204:207], v[184:187], v[136:139]
    v_mfma_f32_16x16x32_bf16 v[140:143], v[204:207], v[188:191], v[140:143]
    s_add_u32 m0, s36, 32768
    s_nop 0
    buffer_load_dwordx4 v220, s[12:15], s40 offen lds
    v_mfma_f32_16x16x32_bf16 v[144:147], v[208:211], v[176:179], v[144:147]
    ds_read_b64_tr_b16 v[204:205], v215 offset:0
    v_mfma_f32_16x16x32_bf16 v[148:151], v[208:211], v[180:183], v[148:151]
    ds_read_b64_tr_b16 v[206:207], v215 offset:512
    v_mfma_f32_16x16x32_bf16 v[152:155], v[208:211], v[184:187], v[152:155]
    v_mfma_f32_16x16x32_bf16 v[156:159], v[208:211], v[188:191], v[156:159]
    s_add_u32 m0, s36, 40960
    s_nop 0
    buffer_load_dwordx4 v221, s[12:15], s40 offen lds
    s_add_u32 s46, s46, 1
    s_branch L_p1_E_loop
L_p1_E_last:
    s_lshl_b32 s47, s37, 3
    s_and_b32 s48, s3, 6
    s_add_u32 s47, s47, s48
    s_cmp_lt_u32 s59, 32
    s_cselect_b32 s56, 0x3e8293ee, 1.0
    s_mov_b32 s57, s56
    s_lshl_b32 s48, s59, 17
    s_lshl_b32 s49, s47, 11
    s_add_u32 s48, s48, s49
    s_sub_u32 s50, s59, 32
    s_lshl_b32 s50, s50, 18
    s_lshl_b32 s49, s47, 12
    s_add_u32 s50, s50, s49
    s_add_u32 s50, s50, 4194304
    s_cmp_lt_u32 s59, 32
    s_cselect_b32 s41, s48, s50
    s_cselect_b32 s48, 1, 2
    s_lshl_b32 s48, s48, 11
    s_add_u32 s42, s41, s48
    s_waitcnt lgkmcnt(4)
    v_mfma_f32_16x16x32_bf16 v[0:3], v[192:195], v[160:163], v[0:3]
    ds_read_b128 v[176:179], v213 offset:32768
    ds_read_b64_tr_b16 v[208:209], v218 offset:45056
    v_mfma_f32_16x16x32_bf16 v[4:7], v[192:195], v[164:167], v[4:7]
    ds_read_b128 v[180:183], v213 offset:34816
    ds_read_b64_tr_b16 v[210:211], v218 offset:45568
    v_mfma_f32_16x16x32_bf16 v[8:11], v[192:195], v[168:171], v[8:11]
    v_mfma_f32_16x16x32_bf16 v[12:15], v[192:195], v[172:175], v[12:15]
    v_mfma_f32_16x16x32_bf16 v[16:19], v[196:199], v[160:163], v[16:19]
    ds_read_b128 v[184:187], v213 offset:36864
    ds_read_b64_tr_b16 v[192:193], v219 offset:45056
    v_mfma_f32_16x16x32_bf16 v[20:23], v[196:199], v[164:167], v[20:23]
    ds_read_b128 v[188:191], v213 offset:38912
    ds_read_b64_tr_b16 v[194:195], v219 offset:45568
    v_mfma_f32_16x16x32_bf16 v[24:27], v[196:199], v[168:171], v[24:27]
    v_mfma_f32_16x16x32_bf16 v[28:31], v[196:199], v[172:175], v[28:31]
    s_waitcnt lgkmcnt(4)
    v_mfma_f32_16x16x32_bf16 v[32:35], v[200:203], v[160:163], v[32:35]
    ds_read_b64_tr_b16 v[196:197], v214 offset:49152
    v_mfma_f32_16x16x32_bf16 v[36:39], v[200:203], v[164:167], v[36:39]
    ds_read_b64_tr_b16 v[198:199], v214 offset:49664
    v_mfma_f32_16x16x32_bf16 v[40:43], v[200:203], v[168:171], v[40:43]
    v_mfma_f32_16x16x32_bf16 v[44:47], v[200:203], v[172:175], v[44:47]
    v_mfma_f32_16x16x32_bf16 v[48:51], v[204:207], v[160:163], v[48:51]
    ds_read_b64_tr_b16 v[200:201], v215 offset:49152
    v_mfma_f32_16x16x32_bf16 v[52:55], v[204:207], v[164:167], v[52:55]
    ds_read_b64_tr_b16 v[202:203], v215 offset:49664
    v_mfma_f32_16x16x32_bf16 v[56:59], v[204:207], v[168:171], v[56:59]
    v_mfma_f32_16x16x32_bf16 v[60:63], v[204:207], v[172:175], v[60:63]
    s_waitcnt lgkmcnt(4)
    v_mfma_f32_16x16x32_bf16 v[0:3], v[208:211], v[176:179], v[0:3]
    ds_read_b64_tr_b16 v[204:205], v216 offset:40960
    v_mfma_f32_16x16x32_bf16 v[4:7], v[208:211], v[180:183], v[4:7]
    ds_read_b64_tr_b16 v[206:207], v216 offset:41472
    v_mfma_f32_16x16x32_bf16 v[8:11], v[208:211], v[184:187], v[8:11]
    v_mfma_f32_16x16x32_bf16 v[12:15], v[208:211], v[188:191], v[12:15]
    v_mfma_f32_16x16x32_bf16 v[16:19], v[192:195], v[176:179], v[16:19]
    ds_read_b64_tr_b16 v[208:209], v217 offset:40960
    v_mfma_f32_16x16x32_bf16 v[20:23], v[192:195], v[180:183], v[20:23]
    ds_read_b64_tr_b16 v[210:211], v217 offset:41472
    v_mfma_f32_16x16x32_bf16 v[24:27], v[192:195], v[184:187], v[24:27]
    v_mfma_f32_16x16x32_bf16 v[28:31], v[192:195], v[188:191], v[28:31]
    s_waitcnt lgkmcnt(4)
    v_mfma_f32_16x16x32_bf16 v[64:67], v[196:199], v[160:163], v[64:67]
    ds_read_b64_tr_b16 v[192:193], v216 offset:49152
    v_mfma_f32_16x16x32_bf16 v[68:71], v[196:199], v[164:167], v[68:71]
    ds_read_b64_tr_b16 v[194:195], v216 offset:49664
    v_mfma_f32_16x16x32_bf16 v[72:75], v[196:199], v[168:171], v[72:75]
    v_mfma_f32_16x16x32_bf16 v[76:79], v[196:199], v[172:175], v[76:79]
    v_mfma_f32_16x16x32_bf16 v[80:83], v[200:203], v[160:163], v[80:83]
    ds_read_b64_tr_b16 v[196:197], v217 offset:49152
    v_mfma_f32_16x16x32_bf16 v[84:87], v[200:203], v[164:167], v[84:87]
    ds_read_b64_tr_b16 v[198:199], v217 offset:49664
    v_mfma_f32_16x16x32_bf16 v[88:91], v[200:203], v[168:171], v[88:91]
    v_mfma_f32_16x16x32_bf16 v[92:95], v[200:203], v[172:175], v[92:95]
    s_waitcnt lgkmcnt(4)
    v_mfma_f32_16x16x32_bf16 v[96:99], v[204:207], v[160:163], v[96:99]
    ds_read_b64_tr_b16 v[200:201], v214 offset:45056
    v_pk_mul_f32 v[0:1], v[0:1], s[56:57]
    v_pk_mul_f32 v[2:3], v[2:3], s[56:57]
    v_mfma_f32_16x16x32_bf16 v[100:103], v[204:207], v[164:167], v[100:103]
    ds_read_b64_tr_b16 v[202:203], v214 offset:45568
    v_pk_mul_f32 v[16:17], v[16:17], s[56:57]
    v_pk_mul_f32 v[18:19], v[18:19], s[56:57]
    v_mfma_f32_16x16x32_bf16 v[104:107], v[204:207], v[168:171], v[104:107]
    v_cvt_pk_bf16_f32 v0, v0, v1
    v_cvt_pk_bf16_f32 v1, v2, v3
    v_mfma_f32_16x16x32_bf16 v[108:111], v[204:207], v[172:175], v[108:111]
    v_cvt_pk_bf16_f32 v2, v16, v17
    v_cvt_pk_bf16_f32 v3, v18, v19
    v_mfma_f32_16x16x32_bf16 v[112:115], v[208:211], v[160:163], v[112:115]
    ds_read_b64_tr_b16 v[204:205], v215 offset:45056
    buffer_store_dwordx4 v[0:3], v230, s[4:7], s41 offen offset:0 sc1
    v_pk_mul_f32 v[4:5], v[4:5], s[56:57]
    v_mfma_f32_16x16x32_bf16 v[116:119], v[208:211], v[164:167], v[116:119]
    ds_read_b64_tr_b16 v[206:207], v215 offset:45568
    v_pk_mul_f32 v[6:7], v[6:7], s[56:57]
    v_pk_mul_f32 v[20:21], v[20:21], s[56:57]
    v_mfma_f32_16x16x32_bf16 v[120:123], v[208:211], v[168:171], v[120:123]
    v_pk_mul_f32 v[22:23], v[22:23], s[56:57]
    v_cvt_pk_bf16_f32 v4, v4, v5
    v_mfma_f32_16x16x32_bf16 v[124:127], v[208:211], v[172:175], v[124:127]
    v_cvt_pk_bf16_f32 v5, v6, v7
    v_cvt_pk_bf16_f32 v6, v20, v21
    s_waitcnt lgkmcnt(4)
    v_mfma_f32_16x16x32_bf16 v[128:131], v[192:195], v[160:163], v[128:131]
    ds_read_b64_tr_b16 v[208:209], v214 offset:53248
    v_cvt_pk_bf16_f32 v7, v22, v23
    buffer_store_dwordx4 v[4:7], v230, s[4:7], s41 offen offset:128 sc1
    v_mfma_f32_16x16x32_bf16 v[132:135], v[192:195], v[164:167], v[132:135]
    ds_read_b64_tr_b16 v[210:211], v214 offset:53760
    v_pk_mul_f32 v[8:9], v[8:9], s[56:57]
    v_pk_mul_f32 v[10:11], v[10:11], s[56:57]
    v_mfma_f32_16x16x32_bf16 v[136:139], v[192:195], v[168:171], v[136:139]
    v_pk_mul_f32 v[24:25], v[24:25], s[56:57]
    v_pk_mul_f32 v[26:27], v[26:27], s[56:57]
    v_mfma_f32_16x16x32_bf16 v[140:143], v[192:195], v[172:175], v[140:143]
    v_cvt_pk_bf16_f32 v8, v8, v9
    v_cvt_pk_bf16_f32 v9, v10, v11
    v_mfma_f32_16x16x32_bf16 v[144:147], v[196:199], v[160:163], v[144:147]
    ds_read_b64_tr_b16 v[192:193], v215 offset:53248
    v_cvt_pk_bf16_f32 v10, v24, v25
    v_cvt_pk_bf16_f32 v11, v26, v27
    v_mfma_f32_16x16x32_bf16 v[148:151], v[196:199], v[164:167], v[148:151]
    ds_read_b64_tr_b16 v[194:195], v215 offset:53760
    buffer_store_dwordx4 v[8:11], v230, s[4:7], s42 offen offset:0 sc1
    v_pk_mul_f32 v[12:13], v[12:13], s[56:57]
    v_mfma_f32_16x16x32_bf16 v[152:155], v[196:199], v[168:171], v[152:155]
    v_pk_mul_f32 v[14:15], v[14:15], s[56:57]
    v_pk_mul_f32 v[28:29], v[28:29], s[56:57]
    v_mfma_f32_16x16x32_bf16 v[156:159], v[196:199], v[172:175], v[156:159]
    v_pk_mul_f32 v[30:31], v[30:31], s[56:57]
    v_cvt_pk_bf16_f32 v12, v12, v13
    s_waitcnt lgkmcnt(4)
    v_mfma_f32_16x16x32_bf16 v[32:35], v[200:203], v[176:179], v[32:35]
    ds_read_b64_tr_b16 v[196:197], v216 offset:45056
    v_cvt_pk_bf16_f32 v13, v14, v15
    v_cvt_pk_bf16_f32 v14, v28, v29
    v_mfma_f32_16x16x32_bf16 v[36:39], v[200:203], v[180:183], v[36:39]
    ds_read_b64_tr_b16 v[198:199], v216 offset:45568
    v_cvt_pk_bf16_f32 v15, v30, v31
    buffer_store_dwordx4 v[12:15], v230, s[4:7], s42 offen offset:128 sc1
    v_mfma_f32_16x16x32_bf16 v[40:43], v[200:203], v[184:187], v[40:43]
    v_mfma_f32_16x16x32_bf16 v[44:47], v[200:203], v[188:191], v[44:47]
    v_mfma_f32_16x16x32_bf16 v[48:51], v[204:207], v[176:179], v[48:51]
    ds_read_b64_tr_b16 v[200:201], v217 offset:45056
    v_mfma_f32_16x16x32_bf16 v[52:55], v[204:207], v[180:183], v[52:55]
    ds_read_b64_tr_b16 v[202:203], v217 offset:45568
    v_mfma_f32_16x16x32_bf16 v[56:59], v[204:207], v[184:187], v[56:59]
    v_mfma_f32_16x16x32_bf16 v[60:63], v[204:207], v[188:191], v[60:63]
    s_waitcnt lgkmcnt(4)
    v_mfma_f32_16x16x32_bf16 v[64:67], v[208:211], v[176:179], v[64:67]
    ds_read_b64_tr_b16 v[204:205], v216 offset:53248
    v_mfma_f32_16x16x32_bf16 v[68:71], v[208:211], v[180:183], v[68:71]
    ds_read_b64_tr_b16 v[206:207], v216 offset:53760
    v_mfma_f32_16x16x32_bf16 v[72:75], v[208:211], v[184:187], v[72:75]
    v_mfma_f32_16x16x32_bf16 v[76:79], v[208:211], v[188:191], v[76:79]
    v_mfma_f32_16x16x32_bf16 v[80:83], v[192:195], v[176:179], v[80:83]
    ds_read_b64_tr_b16 v[208:209], v217 offset:53248
    v_mfma_f32_16x16x32_bf16 v[84:87], v[192:195], v[180:183], v[84:87]
    ds_read_b64_tr_b16 v[210:211], v217 offset:53760
    v_mfma_f32_16x16x32_bf16 v[88:91], v[192:195], v[184:187], v[88:91]
    v_mfma_f32_16x16x32_bf16 v[92:95], v[192:195], v[188:191], v[92:95]
    s_waitcnt lgkmcnt(4)
    v_mfma_f32_16x16x32_bf16 v[96:99], v[196:199], v[176:179], v[96:99]
    v_mfma_f32_16x16x32_bf16 v[100:103], v[196:199], v[180:183], v[100:103]
    v_mfma_f32_16x16x32_bf16 v[104:107], v[196:199], v[184:187], v[104:107]
    v_mfma_f32_16x16x32_bf16 v[108:111], v[196:199], v[188:191], v[108:111]
    v_mfma_f32_16x16x32_bf16 v[112:115], v[200:203], v[176:179], v[112:115]
    v_mfma_f32_16x16x32_bf16 v[116:119], v[200:203], v[180:183], v[116:119]
    v_mfma_f32_16x16x32_bf16 v[120:123], v[200:203], v[184:187], v[120:123]
    v_mfma_f32_16x16x32_bf16 v[124:127], v[200:203], v[188:191], v[124:127]
    s_waitcnt lgkmcnt(0)
    v_mfma_f32_16x16x32_bf16 v[128:131], v[204:207], v[176:179], v[128:131]
    v_mfma_f32_16x16x32_bf16 v[132:135], v[204:207], v[180:183], v[132:135]
    v_mfma_f32_16x16x32_bf16 v[136:139], v[204:207], v[184:187], v[136:139]
    v_mfma_f32_16x16x32_bf16 v[140:143], v[204:207], v[188:191], v[140:143]
    v_mfma_f32_16x16x32_bf16 v[144:147], v[208:211], v[176:179], v[144:147]
    v_mfma_f32_16x16x32_bf16 v[148:151], v[208:211], v[180:183], v[148:151]
    v_mfma_f32_16x16x32_bf16 v[152:155], v[208:211], v[184:187], v[152:155]
    v_mfma_f32_16x16x32_bf16 v[156:159], v[208:211], v[188:191], v[156:159]
    s_lshr_b32 s48, s47, 2
    s_mul_i32 s48, s48, 144
    s_add_u32 s48, s48, s58
    s_lshl_b32 s48, s48, 13
    s_and_b32 s49, s47, 2
    s_lshl_b32 s49, s49, 11
    s_add_u32 s48, s48, s49
    s_add_u32 s78, s48, 12582912
    s_add_u32 s79, s78, 8192
    s_waitcnt vmcnt(0)
    s_barrier
    s_cmp_lg_u32 s3, 0
    s_cbranch_scc1 L_p1_E_flag
    s_lshl_b32 s49, s2, 7
    s_add_u32 s49, s49, 31473664
    v_mov_b32 v248, 1
    v_mov_b32 v249, 0
    s_mov_b64 exec, 1
    buffer_store_dword v248, v249, s[4:7], s49 offen sc1
    s_mov_b64 exec, -1
L_p1_E_flag:
    v_pk_mul_f32 v[160:161], v[32:33], s[52:53]
    v_pk_mul_f32 v[162:163], v[34:35], s[52:53]
    v_pk_mul_f32 v[164:165], v[48:49], s[52:53]
    v_pk_mul_f32 v[166:167], v[50:51], s[52:53]
    v_pk_mul_f32 v[168:169], v[36:37], s[52:53]
    v_pk_mul_f32 v[170:171], v[38:39], s[52:53]
    v_pk_mul_f32 v[172:173], v[52:53], s[52:53]
    v_pk_mul_f32 v[174:175], v[54:55], s[52:53]
    v_exp_f32 v160, v160
    v_exp_f32 v161, v161
    v_exp_f32 v162, v162
    v_exp_f32 v163, v163
    v_exp_f32 v164, v164
    v_exp_f32 v165, v165
    v_exp_f32 v166, v166
    v_exp_f32 v167, v167
    v_exp_f32 v168, v168
    v_exp_f32 v169, v169
    v_exp_f32 v170, v170
    v_exp_f32 v171, v171
    v_exp_f32 v172, v172
    v_exp_f32 v173, v173
    v_exp_f32 v174, v174
    v_exp_f32 v175, v175
    v_pk_add_f32 v[160:161], v[160:161], s[54:55]
    v_pk_add_f32 v[162:163], v[162:163], s[54:55]
    v_pk_add_f32 v[164:165], v[164:165], s[54:55]
    v_pk_add_f32 v[166:167], v[166:167], s[54:55]
    v_pk_add_f32 v[168:169], v[168:169], s[54:55]
    v_pk_add_f32 v[170:171], v[170:171], s[54:55]
    v_pk_add_f32 v[172:173], v[172:173], s[54:55]
    v_pk_add_f32 v[174:175], v[174:175], s[54:55]
    v_rcp_f32 v160, v160
    v_rcp_f32 v161, v161
    v_rcp_f32 v162, v162
    v_rcp_f32 v163, v163
    v_rcp_f32 v164, v164
    v_rcp_f32 v165, v165
    v_rcp_f32 v166, v166
    v_rcp_f32 v167, v167
    v_rcp_f32 v168, v168
    v_rcp_f32 v169, v169
    v_rcp_f32 v170, v170
    v_rcp_f32 v171, v171
    v_rcp_f32 v172, v172
    v_rcp_f32 v173, v173
    v_rcp_f32 v174, v174
    v_rcp_f32 v175, v175
    v_pk_mul_f32 v[32:33], v[32:33], v[160:161]
    v_pk_mul_f32 v[34:35], v[34:35], v[162:163]
    v_pk_mul_f32 v[48:49], v[48:49], v[164:165]
    v_pk_mul_f32 v[50:51], v[50:51], v[166:167]
    v_pk_mul_f32 v[36:37], v[36:37], v[168:169]
    v_pk_mul_f32 v[38:39], v[38:39], v[170:171]
    v_pk_mul_f32 v[52:53], v[52:53], v[172:173]
    v_pk_mul_f32 v[54:55], v[54:55], v[174:175]
    v_pk_mul_f32 v[32:33], v[32:33], v[64:65]
    v_pk_mul_f32 v[34:35], v[34:35], v[66:67]
    v_pk_mul_f32 v[48:49], v[48:49], v[80:81]
    v_pk_mul_f32 v[50:51], v[50:51], v[82:83]
    v_pk_mul_f32 v[36:37], v[36:37], v[68:69]
    v_pk_mul_f32 v[38:39], v[38:39], v[70:71]
    v_pk_mul_f32 v[52:53], v[52:53], v[84:85]
    v_pk_mul_f32 v[54:55], v[54:55], v[86:87]
    v_cvt_pk_bf16_f32 v192, v32, v33
    v_cvt_pk_bf16_f32 v193, v34, v35
    v_cvt_pk_bf16_f32 v194, v48, v49
    v_cvt_pk_bf16_f32 v195, v50, v51
    v_cvt_pk_bf16_f32 v196, v36, v37
    v_cvt_pk_bf16_f32 v197, v38, v39
    v_cvt_pk_bf16_f32 v198, v52, v53
    v_cvt_pk_bf16_f32 v199, v54, v55
    v_pk_mul_f32 v[176:177], v[40:41], s[52:53]
    v_pk_mul_f32 v[178:179], v[42:43], s[52:53]
    v_pk_mul_f32 v[180:181], v[56:57], s[52:53]
    v_pk_mul_f32 v[182:183], v[58:59], s[52:53]
    v_pk_mul_f32 v[184:185], v[44:45], s[52:53]
    v_pk_mul_f32 v[186:187], v[46:47], s[52:53]
    v_pk_mul_f32 v[188:189], v[60:61], s[52:53]
    v_pk_mul_f32 v[190:191], v[62:63], s[52:53]
    v_exp_f32 v176, v176
    v_exp_f32 v177, v177
    v_exp_f32 v178, v178
    v_exp_f32 v179, v179
    v_exp_f32 v180, v180
    v_exp_f32 v181, v181
    v_exp_f32 v182, v182
    v_exp_f32 v183, v183
    v_exp_f32 v184, v184
    v_exp_f32 v185, v185
    v_exp_f32 v186, v186
    v_exp_f32 v187, v187
    v_exp_f32 v188, v188
    v_exp_f32 v189, v189
    v_exp_f32 v190, v190
    v_exp_f32 v191, v191
    v_pk_add_f32 v[176:177], v[176:177], s[54:55]
    v_pk_add_f32 v[178:179], v[178:179], s[54:55]
    v_pk_add_f32 v[180:181], v[180:181], s[54:55]
    v_pk_add_f32 v[182:183], v[182:183], s[54:55]
    v_pk_add_f32 v[184:185], v[184:185], s[54:55]
    v_pk_add_f32 v[186:187], v[186:187], s[54:55]
    v_pk_add_f32 v[188:189], v[188:189], s[54:55]
    v_pk_add_f32 v[190:191], v[190:191], s[54:55]
    v_rcp_f32 v176, v176
    v_rcp_f32 v177, v177
    v_rcp_f32 v178, v178
    v_rcp_f32 v179, v179
    v_rcp_f32 v180, v180
    v_rcp_f32 v181, v181
    v_rcp_f32 v182, v182
    v_rcp_f32 v183, v183
    v_rcp_f32 v184, v184
    v_rcp_f32 v185, v185
    v_rcp_f32 v186, v186
    v_rcp_f32 v187, v187
    v_rcp_f32 v188, v188
    v_rcp_f32 v189, v189
    v_rcp_f32 v190, v190
    v_rcp_f32 v191, v191
    v_pk_mul_f32 v[40:41], v[40:41], v[176:177]
    v_pk_mul_f32 v[42:43], v[42:43], v[178:179]
    v_pk_mul_f32 v[56:57], v[56:57], v[180:181]
    v_pk_mul_f32 v[58:59], v[58:59], v[182:183]
    v_pk_mul_f32 v[44:45], v[44:45], v[184:185]
    v_pk_mul_f32 v[46:47], v[46:47], v[186:187]
    v_pk_mul_f32 v[60:61], v[60:61], v[188:189]
    v_pk_mul_f32 v[62:63], v[62:63], v[190:191]
    v_pk_mul_f32 v[40:41], v[40:41], v[72:73]
    v_pk_mul_f32 v[42:43], v[42:43], v[74:75]
    v_pk_mul_f32 v[56:57], v[56:57], v[88:89]
    v_pk_mul_f32 v[58:59], v[58:59], v[90:91]
    v_pk_mul_f32 v[44:45], v[44:45], v[76:77]
    v_pk_mul_f32 v[46:47], v[46:47], v[78:79]
    v_pk_mul_f32 v[60:61], v[60:61], v[92:93]
    v_pk_mul_f32 v[62:63], v[62:63], v[94:95]
    v_cvt_pk_bf16_f32 v200, v40, v41
    v_cvt_pk_bf16_f32 v201, v42, v43
    v_cvt_pk_bf16_f32 v202, v56, v57
    v_cvt_pk_bf16_f32 v203, v58, v59
    v_cvt_pk_bf16_f32 v204, v44, v45
    v_cvt_pk_bf16_f32 v205, v46, v47
    v_cvt_pk_bf16_f32 v206, v60, v61
    v_cvt_pk_bf16_f32 v207, v62, v63
    v_pk_mul_f32 v[160:161], v[96:97], s[52:53]
    v_pk_mul_f32 v[162:163], v[98:99], s[52:53]
    v_pk_mul_f32 v[164:165], v[112:113], s[52:53]
    v_pk_mul_f32 v[166:167], v[114:115], s[52:53]
    v_pk_mul_f32 v[168:169], v[100:101], s[52:53]
    v_pk_mul_f32 v[170:171], v[102:103], s[52:53]
    v_pk_mul_f32 v[172:173], v[116:117], s[52:53]
    v_pk_mul_f32 v[174:175], v[118:119], s[52:53]
    v_exp_f32 v160, v160
    v_exp_f32 v161, v161
    v_exp_f32 v162, v162
    v_exp_f32 v163, v163
    v_exp_f32 v164, v164
    v_exp_f32 v165, v165
    v_exp_f32 v166, v166
    v_exp_f32 v167, v167
    v_exp_f32 v168, v168
    v_exp_f32 v169, v169
    v_exp_f32 v170, v170
    v_exp_f32 v171, v171
    v_exp_f32 v172, v172
    v_exp_f32 v173, v173
    v_exp_f32 v174, v174
    v_exp_f32 v175, v175
    v_pk_add_f32 v[160:161], v[160:161], s[54:55]
    v_pk_add_f32 v[162:163], v[162:163], s[54:55]
    v_pk_add_f32 v[164:165], v[164:165], s[54:55]
    v_pk_add_f32 v[166:167], v[166:167], s[54:55]
    v_pk_add_f32 v[168:169], v[168:169], s[54:55]
    v_pk_add_f32 v[170:171], v[170:171], s[54:55]
    v_pk_add_f32 v[172:173], v[172:173], s[54:55]
    v_pk_add_f32 v[174:175], v[174:175], s[54:55]
    v_rcp_f32 v160, v160
    v_rcp_f32 v161, v161
    v_rcp_f32 v162, v162
    v_rcp_f32 v163, v163
    v_rcp_f32 v164, v164
    v_rcp_f32 v165, v165
    v_rcp_f32 v166, v166
    v_rcp_f32 v167, v167
    v_rcp_f32 v168, v168
    v_rcp_f32 v169, v169
    v_rcp_f32 v170, v170
    v_rcp_f32 v171, v171
    v_rcp_f32 v172, v172
    v_rcp_f32 v173, v173
    v_rcp_f32 v174, v174
    v_rcp_f32 v175, v175
    v_pk_mul_f32 v[96:97], v[96:97], v[160:161]
    v_pk_mul_f32 v[98:99], v[98:99], v[162:163]
    v_pk_mul_f32 v[112:113], v[112:113], v[164:165]
    v_pk_mul_f32 v[114:115], v[114:115], v[166:167]
    v_pk_mul_f32 v[100:101], v[100:101], v[168:169]
    v_pk_mul_f32 v[102:103], v[102:103], v[170:171]
    v_pk_mul_f32 v[116:117], v[116:117], v[172:173]
    v_pk_mul_f32 v[118:119], v[118:119], v[174:175]
    v_pk_mul_f32 v[96:97], v[96:97], v[128:129]
    v_pk_mul_f32 v[98:99], v[98:99], v[130:131]
    v_pk_mul_f32 v[112:113], v[112:113], v[144:145]
    v_pk_mul_f32 v[114:115], v[114:115], v[146:147]
    v_pk_mul_f32 v[100:101], v[100:101], v[132:133]
    v_pk_mul_f32 v[102:103], v[102:103], v[134:135]
    v_pk_mul_f32 v[116:117], v[116:117], v[148:149]
    v_pk_mul_f32 v[118:119], v[118:119], v[150:151]
    v_cvt_pk_bf16_f32 v208, v96, v97
    v_cvt_pk_bf16_f32 v209, v98, v99
    v_cvt_pk_bf16_f32 v210, v112, v113
    v_cvt_pk_bf16_f32 v211, v114, v115
    v_cvt_pk_bf16_f32 v212, v100, v101
    v_cvt_pk_bf16_f32 v213, v102, v103
    v_cvt_pk_bf16_f32 v214, v116, v117
    v_cvt_pk_bf16_f32 v215, v118, v119
    v_pk_mul_f32 v[176:177], v[104:105], s[52:53]
    v_pk_mul_f32 v[178:179], v[106:107], s[52:53]
    v_pk_mul_f32 v[180:181], v[120:121], s[52:53]
    v_pk_mul_f32 v[182:183], v[122:123], s[52:53]
    v_pk_mul_f32 v[184:185], v[108:109], s[52:53]
    v_pk_mul_f32 v[186:187], v[110:111], s[52:53]
    v_pk_mul_f32 v[188:189], v[124:125], s[52:53]
    v_pk_mul_f32 v[190:191], v[126:127], s[52:53]
    v_exp_f32 v176, v176
    v_exp_f32 v177, v177
    v_exp_f32 v178, v178
    v_exp_f32 v179, v179
    v_exp_f32 v180, v180
    v_exp_f32 v181, v181
    v_exp_f32 v182, v182
    v_exp_f32 v183, v183
    v_exp_f32 v184, v184
    v_exp_f32 v185, v185
    v_exp_f32 v186, v186
    v_exp_f32 v187, v187
    v_exp_f32 v188, v188
    v_exp_f32 v189, v189
    v_exp_f32 v190, v190
    v_exp_f32 v191, v191
    v_pk_add_f32 v[176:177], v[176:177], s[54:55]
    v_pk_add_f32 v[178:179], v[178:179], s[54:55]
    v_pk_add_f32 v[180:181], v[180:181], s[54:55]
    v_pk_add_f32 v[182:183], v[182:183], s[54:55]
    v_pk_add_f32 v[184:185], v[184:185], s[54:55]
    v_pk_add_f32 v[186:187], v[186:187], s[54:55]
    v_pk_add_f32 v[188:189], v[188:189], s[54:55]
    v_pk_add_f32 v[190:191], v[190:191], s[54:55]
    v_rcp_f32 v176, v176
    v_rcp_f32 v177, v177
    v_rcp_f32 v178, v178
    v_rcp_f32 v179, v179
    v_rcp_f32 v180, v180
    v_rcp_f32 v181, v181
    v_rcp_f32 v182, v182
    v_rcp_f32 v183, v183
    v_rcp_f32 v184, v184
    v_rcp_f32 v185, v185
    v_rcp_f32 v186, v186
    v_rcp_f32 v187, v187
    v_rcp_f32 v188, v188
    v_rcp_f32 v189, v189
    v_rcp_f32 v190, v190
    v_rcp_f32 v191, v191
    v_pk_mul_f32 v[104:105], v[104:105], v[176:177]
    v_pk_mul_f32 v[106:107], v[106:107], v[178:179]
    v_pk_mul_f32 v[120:121], v[120:121], v[180:181]
    v_pk_mul_f32 v[122:123], v[122:123], v[182:183]
    v_pk_mul_f32 v[108:109], v[108:109], v[184:185]
    v_pk_mul_f32 v[110:111], v[110:111], v[186:187]
    v_pk_mul_f32 v[124:125], v[124:125], v[188:189]
    v_pk_mul_f32 v[126:127], v[126:127], v[190:191]
    v_pk_mul_f32 v[104:105], v[104:105], v[136:137]
    v_pk_mul_f32 v[106:107], v[106:107], v[138:139]
    v_pk_mul_f32 v[120:121], v[120:121], v[152:153]
    v_pk_mul_f32 v[122:123], v[122:123], v[154:155]
    v_pk_mul_f32 v[108:109], v[108:109], v[140:141]
    v_pk_mul_f32 v[110:111], v[110:111], v[142:143]
    v_pk_mul_f32 v[124:125], v[124:125], v[156:157]
    v_pk_mul_f32 v[126:127], v[126:127], v[158:159]
    v_cvt_pk_bf16_f32 v216, v104, v105
    v_cvt_pk_bf16_f32 v217, v106, v107
    v_cvt_pk_bf16_f32 v218, v120, v121
    v_cvt_pk_bf16_f32 v219, v122, v123
    v_cvt_pk_bf16_f32 v220, v108, v109
    v_cvt_pk_bf16_f32 v221, v110, v111
    v_cvt_pk_bf16_f32 v222, v124, v125
    v_cvt_pk_bf16_f32 v223, v126, v127
    s_branch L_p1_gate
L_p1_O:
    s_add_u32 m0, s36, 0
    s_nop 0
    buffer_load_dwordx4 v220, s[12:15], s40 offen lds
    s_add_u32 m0, s36, 8192
    s_nop 0
    buffer_load_dwordx4 v221, s[12:15], s40 offen lds
    s_add_u32 m0, s36, 16384
    s_nop 0
    buffer_load_dwordx4 v222, s[12:15], s40 offen lds
    s_add_u32 m0, s36, 24576
    s_nop 0
    buffer_load_dwordx4 v223, s[12:15], s40 offen lds
    s_add_u32 s40, s40, 128
    s_add_u32 m0, s36, 65536
    s_nop 0
    buffer_load_dwordx4 v225, s[20:23], s41 offen lds
    s_add_u32 s41, s41, 458752
    s_add_u32 m0, s36, 73728
    s_nop 0
    buffer_load_dwordx4 v225, s[24:27], s42 offen lds
    s_add_u32 s42, s42, 458752
    s_add_u32 m0, s36, 81920
    s_nop 0
    buffer_load_dwordx4 v224, s[16:19], s43 offen lds
    s_add_u32 s43, s43, 393216
    s_add_u32 m0, s36, 90112
    s_nop 0
    buffer_load_dwordx4 v224, s[16:19], s44 offen lds
    s_add_u32 s44, s44, 393216
    s_add_u32 m0, s36, 98304
    s_nop 0
    buffer_load_dwordx4 v224, s[16:19], s45 offen lds
    s_add_u32 s45, s45, 393216
    buffer_load_dword v227, v226, s[32:35], s63 offen
    s_add_u32 s63, s63, s100
    buffer_load_dword v227, v226, s[32:35], s63 offen
    s_add_u32 s63, s63, s100
    s_mov_b32 s28, s64
    s_mov_b32 s29, s65
    s_mov_b32 s30, 2048
    s_mov_b32 s31, 0x00020000
    s_cmp_eq_u32 s3, 6
    s_cselect_b32 s47, 14, 4
    s_lshl_b32 s47, s47, 11
    s_mul_i32 s48, s47, s2
    s_add_u32 s47, s47, s48
    v_and_b32 v232, 15, v228
    v_lshlrev_b32 v232, 7, v232
    s_cmp_gt_u32 s3, 5
    s_cselect_b32 s34, s47, s34
    s_cselect_b32 s63, s48, s63
    s_cselect_b32 s100, 2048, s100
    s_cselect_b64 vcc, -1, 0
    s_nop 1
    v_cndmask_b32 v226, v226, v232, vcc
    s_lshr_b32 s65, s2, 6
    s_add_u32 s65, s65, 1
    s_lshr_b32 s47, s3, 1
    s_lshl_b32 s47, s47, 13
    v_and_b32 v233, 15, v228
    v_lshlrev_b32 v233, 7, v233
    v_add_u32 v235, s47, v233
    v_lshrrev_b32 v233, 1, v228
    v_and_b32 v233, 7, v233
    v_lshrrev_b32 v236, 4, v228
    v_xor_b32 v233, v233, v236
    v_lshlrev_b32 v233, 4, v233
    v_add_u32 v212, v235, v233
    v_xor_b32 v213, 64, v212
    v_lshlrev_b32 v236, 10, v236
    v_lshrrev_b32 v233, 2, v228
    v_and_b32 v233, 3, v233
    v_lshlrev_b32 v235, 7, v233
    v_add_u32 v236, v236, v235
    v_lshlrev_b32 v233, 2, v228
    v_and_b32 v233, 0x60, v233
    v_add_u32 v236, v236, v233
    v_and_b32 v233, 3, v228
    v_lshlrev_b32 v233, 3, v233
    v_add_u32 v236, v236, v233
    s_lshl_b32 s47, s51, 13
    s_add_u32 s47, s47, 90112
    s_mov_b32 s48, 65536
    s_lshl_b32 s58, s38, 1
    s_add_u32 s58, s58, 96
    s_add_u32 s58, s58, s51
    s_lshl_b32 s60, s38, 2
    s_lshl_b32 s49, s51, 1
    s_add_u32 s60, s60, s49
    v_xor_b32 v214, 0, v236
    v_add_u32 v214, s47, v214
    v_xor_b32 v215, 32, v236
    v_add_u32 v215, s47, v215
    v_xor_b32 v216, 64, v236
    v_add_u32 v216, s47, v216
    v_xor_b32 v217, 96, v236
    v_add_u32 v217, s47, v217
    s_lshl_b32 s49, s51, 6
    v_xor_b32 v218, s49, v236
    v_add_u32 v218, s48, v218
    v_xor_b32 v219, 32, v218
    v_lshrrev_b32 v233, 3, v228
    v_lshlrev_b32 v233, 8, v233
    v_and_b32 v234, 7, v228
    v_lshlrev_b32 v234, 4, v234
    v_add_u32 v230, v233, v234
    s_mov_b32 s52, 0xbfb8aa3b
    s_mov_b32 s53, 0xbfb8aa3b
    s_mov_b32 s54, 1.0
    s_mov_b32 s55, 1.0
    s_lshl_b32 s47, s2, 3
    s_add_u32 s61, s47, s3
    v_mov_b64 v[0:1], 0
    v_mov_b64 v[2:3], 0
    v_mov_b64 v[4:5], 0
    v_mov_b64 v[6:7], 0
    v_mov_b64 v[8:9], 0
    v_mov_b64 v[10:11], 0
    v_mov_b64 v[12:13], 0
    v_mov_b64 v[14:15], 0
    v_mov_b64 v[16:17], 0
    v_mov_b64 v[18:19], 0
    v_mov_b64 v[20:21], 0
    v_mov_b64 v[22:23], 0
    v_mov_b64 v[24:25], 0
    v_mov_b64 v[26:27], 0
    v_mov_b64 v[28:29], 0
    v_mov_b64 v[30:31], 0
    v_mov_b64 v[32:33], 0
    v_mov_b64 v[34:35], 0
    v_mov_b64 v[36:37], 0
    v_mov_b64 v[38:39], 0
    v_mov_b64 v[40:41], 0
    v_mov_b64 v[42:43], 0
    v_mov_b64 v[44:45], 0
    v_mov_b64 v[46:47], 0
    v_mov_b64 v[48:49], 0
    v_mov_b64 v[50:51], 0
    v_mov_b64 v[52:53], 0
    v_mov_b64 v[54:55], 0
    v_mov_b64 v[56:57], 0
    v_mov_b64 v[58:59], 0
    v_mov_b64 v[60:61], 0
    v_mov_b64 v[62:63], 0
    v_mov_b64 v[64:65], 0
    v_mov_b64 v[66:67], 0
    v_mov_b64 v[68:69], 0
    v_mov_b64 v[70:71], 0
    v_mov_b64 v[72:73], 0
    v_mov_b64 v[74:75], 0
    v_mov_b64 v[76:77], 0
    v_mov_b64 v[78:79], 0
    v_mov_b64 v[80:81], 0
    v_mov_b64 v[82:83], 0
    v_mov_b64 v[84:85], 0
    v_mov_b64 v[86:87], 0
    v_mov_b64 v[88:89], 0
    v_mov_b64 v[90:91], 0
    v_mov_b64 v[92:93], 0
    v_mov_b64 v[94:95], 0
    v_mov_b64 v[96:97], 0
    v_mov_b64 v[98:99], 0
    v_mov_b64 v[100:101], 0
    v_mov_b64 v[102:103], 0
    v_mov_b64 v[104:105], 0
    v_mov_b64 v[106:107], 0
    v_mov_b64 v[108:109], 0
    v_mov_b64 v[110:111], 0
    v_mov_b64 v[112:113], 0
    v_mov_b64 v[114:115], 0
    v_mov_b64 v[116:117], 0
    v_mov_b64 v[118:119], 0
    v_mov_b64 v[120:121], 0
    v_mov_b64 v[122:123], 0
    v_mov_b64 v[124:125], 0
    v_mov_b64 v[126:127], 0
    v_mov_b64 v[128:129], 0
    v_mov_b64 v[130:131], 0
    v_mov_b64 v[132:133], 0
    v_mov_b64 v[134:135], 0
    v_mov_b64 v[136:137], 0
    v_mov_b64 v[138:139], 0
    v_mov_b64 v[140:141], 0
    v_mov_b64 v[142:143], 0
    v_mov_b64 v[144:145], 0
    v_mov_b64 v[146:147], 0
    v_mov_b64 v[148:149], 0
    v_mov_b64 v[150:151], 0
    v_mov_b64 v[152:153], 0
    v_mov_b64 v[154:155], 0
    v_mov_b64 v[156:157], 0
    v_mov_b64 v[158:159], 0
    v_lshlrev_b32 v233, 2, v228
    v_add_u32 v233, 147456, v233
    v_mov_b32 v232, 0
    ds_write_b32 v233, v232
    s_waitcnt lgkmcnt(0)
    s_lshl_b32 s47, s2, 7
    s_add_u32 s47, s47, 31473664
    v_mov_b32 v232, 0
    buffer_store_dword v232, v232, s[4:7], s47 offen sc1
    s_waitcnt vmcnt(3)
    s_barrier
    ds_read_b128 v[160:163], v212 offset:0
    ds_read_b128 v[164:167], v212 offset:2048
    ds_read_b128 v[168:171], v212 offset:4096
    ds_read_b128 v[172:175], v212 offset:6144
    ds_read_b64_tr_b16 v[192:193], v218 offset:16384
    ds_read_b64_tr_b16 v[194:195], v218 offset:16896
    ds_read_b64_tr_b16 v[196:197], v219 offset:16384
    ds_read_b64_tr_b16 v[198:199], v219 offset:16896
    ds_read_b64_tr_b16 v[200:201], v214 offset:0
    ds_read_b64_tr_b16 v[202:203], v214 offset:512
    ds_read_b64_tr_b16 v[204:205], v215 offset:0
    ds_read_b64_tr_b16 v[206:207], v215 offset:512
    s_add_u32 m0, s36, 32768
    s_nop 0
    buffer_load_dwordx4 v220, s[12:15], s40 offen lds
    s_add_u32 m0, s36, 40960
    s_nop 0
    buffer_load_dwordx4 v221, s[12:15], s40 offen lds
    s_mov_b32 s46, 0
.p2align 6
L_p1_O_loop:
    s_waitcnt lgkmcnt(4)
    v_mfma_f32_16x16x32_bf16 v[0:3], v[192:195], v[160:163], v[0:3]
    ds_read_b64_tr_b16 v[208:209], v216 offset:0
    v_mfma_f32_16x16x32_bf16 v[4:7], v[192:195], v[164:167], v[4:7]
    ds_read_b64_tr_b16 v[210:211], v216 offset:512
    v_mfma_f32_16x16x32_bf16 v[8:11], v[192:195], v[168:171], v[8:11]
    v_mfma_f32_16x16x32_bf16 v[12:15], v[192:195], v[172:175], v[12:15]
    s_add_u32 m0, s36, 49152
    s_nop 0
    buffer_load_dwordx4 v222, s[12:15], s40 offen lds
    v_mfma_f32_16x16x32_bf16 v[16:19], v[196:199], v[160:163], v[16:19]
    ds_read_b64_tr_b16 v[192:193], v217 offset:0
    v_mfma_f32_16x16x32_bf16 v[20:23], v[196:199], v[164:167], v[20:23]
    ds_read_b64_tr_b16 v[194:195], v217 offset:512
    v_mfma_f32_16x16x32_bf16 v[24:27], v[196:199], v[168:171], v[24:27]
    v_mfma_f32_16x16x32_bf16 v[28:31], v[196:199], v[172:175], v[28:31]
    s_add_u32 m0, s36, 57344
    s_nop 0
    buffer_load_dwordx4 v223, s[12:15], s40 offen lds
    s_add_u32 s40, s40, 128
    s_waitcnt lgkmcnt(4)
    v_mfma_f32_16x16x32_bf16 v[32:35], v[160:163], v[200:203], v[32:35]
    ds_read_b64_tr_b16 v[196:197], v218 offset:0
    v_mfma_f32_16x16x32_bf16 v[36:39], v[164:167], v[200:203], v[36:39]
    ds_read_b64_tr_b16 v[198:199], v218 offset:512
    v_mfma_f32_16x16x32_bf16 v[40:43], v[168:171], v[200:203], v[40:43]
    ds_read_b128 v[176:179], v213 offset:0
    v_mfma_f32_16x16x32_bf16 v[44:47], v[172:175], v[200:203], v[44:47]
    s_add_u32 m0, s36, 106496
    s_nop 0
    buffer_load_dwordx4 v225, s[20:23], s41 offen lds
    s_add_u32 s41, s41, 458752
    v_mfma_f32_16x16x32_bf16 v[48:51], v[160:163], v[204:207], v[48:51]
    ds_read_b64_tr_b16 v[200:201], v219 offset:0
    v_mfma_f32_16x16x32_bf16 v[52:55], v[164:167], v[204:207], v[52:55]
    ds_read_b64_tr_b16 v[202:203], v219 offset:512
    v_mfma_f32_16x16x32_bf16 v[56:59], v[168:171], v[204:207], v[56:59]
    ds_read_b128 v[180:183], v213 offset:2048
    v_mfma_f32_16x16x32_bf16 v[60:63], v[172:175], v[204:207], v[60:63]
    s_add_u32 m0, s36, 114688
    s_nop 0
    buffer_load_dwordx4 v225, s[24:27], s42 offen lds
    s_add_u32 s42, s42, 458752
    s_waitcnt lgkmcnt(4)
    v_mfma_f32_16x16x32_bf16 v[64:67], v[160:163], v[208:211], v[64:67]
    ds_read_b64_tr_b16 v[204:205], v218 offset:8192
    v_mfma_f32_16x16x32_bf16 v[68:71], v[164:167], v[208:211], v[68:71]
    ds_read_b64_tr_b16 v[206:207], v218 offset:8704
    v_mfma_f32_16x16x32_bf16 v[72:75], v[168:171], v[208:211], v[72:75]
    ds_read_b128 v[184:187], v213 offset:4096
    v_mfma_f32_16x16x32_bf16 v[76:79], v[172:175], v[208:211], v[76:79]
    s_add_u32 m0, s36, 122880
    s_nop 0
    buffer_load_dwordx4 v224, s[16:19], s43 offen lds
    s_add_u32 s43, s43, 393216
    v_mfma_f32_16x16x32_bf16 v[80:83], v[160:163], v[192:195], v[80:83]
    ds_read_b64_tr_b16 v[208:209], v219 offset:8192
    v_mfma_f32_16x16x32_bf16 v[84:87], v[164:167], v[192:195], v[84:87]
    ds_read_b64_tr_b16 v[210:211], v219 offset:8704
    v_mfma_f32_16x16x32_bf16 v[88:91], v[168:171], v[192:195], v[88:91]
    ds_read_b128 v[188:191], v213 offset:6144
    v_mfma_f32_16x16x32_bf16 v[92:95], v[172:175], v[192:195], v[92:95]
    s_add_u32 m0, s36, 131072
    s_nop 0
    buffer_load_dwordx4 v224, s[16:19], s44 offen lds
    s_add_u32 s44, s44, 393216
    s_waitcnt lgkmcnt(4)
    v_mfma_f32_16x16x32_bf16 v[96:99], v[196:199], v[160:163], v[96:99]
    ds_read_b64_tr_b16 v[192:193], v218 offset:20480
    v_mfma_f32_16x16x32_bf16 v[100:103], v[196:199], v[164:167], v[100:103]
    ds_read_b64_tr_b16 v[194:195], v218 offset:20992
    v_mfma_f32_16x16x32_bf16 v[104:107], v[196:199], v[168:171], v[104:107]
    v_mfma_f32_16x16x32_bf16 v[108:111], v[196:199], v[172:175], v[108:111]
    s_add_u32 m0, s36, 139264
    s_nop 0
    buffer_load_dwordx4 v224, s[16:19], s45 offen lds
    s_add_u32 s45, s45, 393216
    v_mfma_f32_16x16x32_bf16 v[112:115], v[200:203], v[160:163], v[112:115]
    ds_read_b64_tr_b16 v[196:197], v219 offset:20480
    v_mfma_f32_16x16x32_bf16 v[116:119], v[200:203], v[164:167], v[116:119]
    ds_read_b64_tr_b16 v[198:199], v219 offset:20992
    v_mfma_f32_16x16x32_bf16 v[120:123], v[200:203], v[168:171], v[120:123]
    v_mfma_f32_16x16x32_bf16 v[124:127], v[200:203], v[172:175], v[124:127]
    buffer_load_dword v227, v226, s[32:35], s63 offen
    s_add_u32 s63, s63, s100
    s_waitcnt lgkmcnt(4)
    v_mfma_f32_16x16x32_bf16 v[128:131], v[204:207], v[160:163], v[128:131]
    ds_read_b64_tr_b16 v[200:201], v214 offset:4096
    v_mfma_f32_16x16x32_bf16 v[132:135], v[204:207], v[164:167], v[132:135]
    ds_read_b64_tr_b16 v[202:203], v214 offset:4608
    v_mfma_f32_16x16x32_bf16 v[136:139], v[204:207], v[168:171], v[136:139]
    v_mfma_f32_16x16x32_bf16 v[140:143], v[204:207], v[172:175], v[140:143]
    v_mfma_f32_16x16x32_bf16 v[144:147], v[208:211], v[160:163], v[144:147]
    ds_read_b64_tr_b16 v[204:205], v215 offset:4096
    v_mfma_f32_16x16x32_bf16 v[148:151], v[208:211], v[164:167], v[148:151]
    ds_read_b64_tr_b16 v[206:207], v215 offset:4608
    v_mfma_f32_16x16x32_bf16 v[152:155], v[208:211], v[168:171], v[152:155]
    v_mfma_f32_16x16x32_bf16 v[156:159], v[208:211], v[172:175], v[156:159]
    s_waitcnt lgkmcnt(4)
    v_mfma_f32_16x16x32_bf16 v[0:3], v[192:195], v[176:179], v[0:3]
    ds_read_b64_tr_b16 v[208:209], v216 offset:4096
    v_mfma_f32_16x16x32_bf16 v[4:7], v[192:195], v[180:183], v[4:7]
    ds_read_b64_tr_b16 v[210:211], v216 offset:4608
    v_mfma_f32_16x16x32_bf16 v[8:11], v[192:195], v[184:187], v[8:11]
    v_mfma_f32_16x16x32_bf16 v[12:15], v[192:195], v[188:191], v[12:15]
    v_mfma_f32_16x16x32_bf16 v[16:19], v[196:199], v[176:179], v[16:19]
    ds_read_b64_tr_b16 v[192:193], v217 offset:4096
    v_mfma_f32_16x16x32_bf16 v[20:23], v[196:199], v[180:183], v[20:23]
    ds_read_b64_tr_b16 v[194:195], v217 offset:4608
    v_mfma_f32_16x16x32_bf16 v[24:27], v[196:199], v[184:187], v[24:27]
    v_mfma_f32_16x16x32_bf16 v[28:31], v[196:199], v[188:191], v[28:31]
    s_waitcnt lgkmcnt(4)
    v_mfma_f32_16x16x32_bf16 v[32:35], v[176:179], v[200:203], v[32:35]
    ds_read_b64_tr_b16 v[196:197], v218 offset:4096
    v_mfma_f32_16x16x32_bf16 v[36:39], v[180:183], v[200:203], v[36:39]
    ds_read_b64_tr_b16 v[198:199], v218 offset:4608
    v_mfma_f32_16x16x32_bf16 v[40:43], v[184:187], v[200:203], v[40:43]
    v_mfma_f32_16x16x32_bf16 v[44:47], v[188:191], v[200:203], v[44:47]
    v_mfma_f32_16x16x32_bf16 v[48:51], v[176:179], v[204:207], v[48:51]
    ds_read_b64_tr_b16 v[200:201], v219 offset:4096
    v_mfma_f32_16x16x32_bf16 v[52:55], v[180:183], v[204:207], v[52:55]
    ds_read_b64_tr_b16 v[202:203], v219 offset:4608
    v_mfma_f32_16x16x32_bf16 v[56:59], v[184:187], v[204:207], v[56:59]
    v_mfma_f32_16x16x32_bf16 v[60:63], v[188:191], v[204:207], v[60:63]
    s_waitcnt lgkmcnt(4)
    v_mfma_f32_16x16x32_bf16 v[64:67], v[176:179], v[208:211], v[64:67]
    ds_read_b64_tr_b16 v[204:205], v218 offset:12288
    v_mfma_f32_16x16x32_bf16 v[68:71], v[180:183], v[208:211], v[68:71]
    ds_read_b64_tr_b16 v[206:207], v218 offset:12800
    v_mfma_f32_16x16x32_bf16 v[72:75], v[184:187], v[208:211], v[72:75]
    v_mfma_f32_16x16x32_bf16 v[76:79], v[188:191], v[208:211], v[76:79]
    v_mfma_f32_16x16x32_bf16 v[80:83], v[176:179], v[192:195], v[80:83]
    ds_read_b64_tr_b16 v[208:209], v219 offset:12288
    v_mfma_f32_16x16x32_bf16 v[84:87], v[180:183], v[192:195], v[84:87]
    ds_read_b64_tr_b16 v[210:211], v219 offset:12800
    v_mfma_f32_16x16x32_bf16 v[88:91], v[184:187], v[192:195], v[88:91]
    v_mfma_f32_16x16x32_bf16 v[92:95], v[188:191], v[192:195], v[92:95]
    s_waitcnt vmcnt(1) lgkmcnt(0)
    s_barrier
    s_cmp_eq_u32 s46, s65
    s_cbranch_scc0 L_p1_O_e0
    s_cmp_lg_u32 s3, 0
    s_cbranch_scc1 L_p1_O_e0
    v_mov_b32 v248, 1
    v_mov_b32 v249, 0
    s_mov_b64 exec, 1
    buffer_atomic_add v248, v249, s[8:11], 0 offen sc1
    s_mov_b64 exec, -1
L_p1_O_e0:
    s_cmp_eq_u32 s46, 7
    s_cbranch_scc0 L_p1_O_e7
    v_mov_b32 v249, 0
    buffer_load_dword v251, v249, s[8:11], 0 offen sc1
    s_lshl_b32 s47, s61, 11
    v_lshlrev_b32 v248, 5, v228
    buffer_load_dwordx4 v[232:235], v248, s[12:15], s47 offen
    buffer_load_dwordx4 v[236:239], v248, s[12:15], s47 offen offset:16
    buffer_load_dwordx4 v[240:243], v248, s[28:31], 0 offen
    buffer_load_dwordx4 v[244:247], v248, s[28:31], 0 offen offset:16
    s_mov_b32 s14, 0
    s_mov_b32 s18, 0
    s_mov_b32 s22, 0
    s_mov_b32 s26, 0
    s_mov_b32 s34, 0
L_p1_O_e7:
    v_mfma_f32_16x16x32_bf16 v[96:99], v[196:199], v[176:179], v[96:99]
    ds_read_b64_tr_b16 v[192:193], v218 offset:57344
    v_mfma_f32_16x16x32_bf16 v[100:103], v[196:199], v[180:183], v[100:103]
    ds_read_b64_tr_b16 v[194:195], v218 offset:57856
    v_mfma_f32_16x16x32_bf16 v[104:107], v[196:199], v[184:187], v[104:107]
    ds_read_b128 v[160:163], v212 offset:32768
    v_mfma_f32_16x16x32_bf16 v[108:111], v[196:199], v[188:191], v[108:111]
    ds_read_b128 v[164:167], v212 offset:34816
    v_mfma_f32_16x16x32_bf16 v[112:115], v[200:203], v[176:179], v[112:115]
    ds_read_b64_tr_b16 v[196:197], v219 offset:57344
    v_mfma_f32_16x16x32_bf16 v[116:119], v[200:203], v[180:183], v[116:119]
    ds_read_b64_tr_b16 v[198:199], v219 offset:57856
    v_mfma_f32_16x16x32_bf16 v[120:123], v[200:203], v[184:187], v[120:123]
    ds_read_b128 v[168:171], v212 offset:36864
    v_mfma_f32_16x16x32_bf16 v[124:127], v[200:203], v[188:191], v[124:127]
    ds_read_b128 v[172:175], v212 offset:38912
    v_mfma_f32_16x16x32_bf16 v[128:131], v[204:207], v[176:179], v[128:131]
    ds_read_b64_tr_b16 v[200:201], v214 offset:40960
    v_mfma_f32_16x16x32_bf16 v[132:135], v[204:207], v[180:183], v[132:135]
    ds_read_b64_tr_b16 v[202:203], v214 offset:41472
    v_mfma_f32_16x16x32_bf16 v[136:139], v[204:207], v[184:187], v[136:139]
    v_mfma_f32_16x16x32_bf16 v[140:143], v[204:207], v[188:191], v[140:143]
    s_add_u32 m0, s36, 0
    s_nop 0
    buffer_load_dwordx4 v220, s[12:15], s40 offen lds
    v_mfma_f32_16x16x32_bf16 v[144:147], v[208:211], v[176:179], v[144:147]
    ds_read_b64_tr_b16 v[204:205], v215 offset:40960
    v_mfma_f32_16x16x32_bf16 v[148:151], v[208:211], v[180:183], v[148:151]
    ds_read_b64_tr_b16 v[206:207], v215 offset:41472
    v_mfma_f32_16x16x32_bf16 v[152:155], v[208:211], v[184:187], v[152:155]
    v_mfma_f32_16x16x32_bf16 v[156:159], v[208:211], v[188:191], v[156:159]
    s_add_u32 m0, s36, 8192
    s_nop 0
    buffer_load_dwordx4 v221, s[12:15], s40 offen lds
    s_cmp_eq_u32 s46, 7
    s_cbranch_scc1 L_p1_O_last
    s_waitcnt lgkmcnt(4)
    v_mfma_f32_16x16x32_bf16 v[0:3], v[192:195], v[160:163], v[0:3]
    ds_read_b64_tr_b16 v[208:209], v216 offset:40960
    v_mfma_f32_16x16x32_bf16 v[4:7], v[192:195], v[164:167], v[4:7]
    ds_read_b64_tr_b16 v[210:211], v216 offset:41472
    v_mfma_f32_16x16x32_bf16 v[8:11], v[192:195], v[168:171], v[8:11]
    v_mfma_f32_16x16x32_bf16 v[12:15], v[192:195], v[172:175], v[12:15]
    s_add_u32 m0, s36, 16384
    s_nop 0
    buffer_load_dwordx4 v222, s[12:15], s40 offen lds
    v_mfma_f32_16x16x32_bf16 v[16:19], v[196:199], v[160:163], v[16:19]
    ds_read_b64_tr_b16 v[192:193], v217 offset:40960
    v_mfma_f32_16x16x32_bf16 v[20:23], v[196:199], v[164:167], v[20:23]
    ds_read_b64_tr_b16 v[194:195], v217 offset:41472
    v_mfma_f32_16x16x32_bf16 v[24:27], v[196:199], v[168:171], v[24:27]
    v_mfma_f32_16x16x32_bf16 v[28:31], v[196:199], v[172:175], v[28:31]
    s_add_u32 m0, s36, 24576
    s_nop 0
    buffer_load_dwordx4 v223, s[12:15], s40 offen lds
    s_add_u32 s40, s40, 128
    s_waitcnt lgkmcnt(4)
    v_mfma_f32_16x16x32_bf16 v[32:35], v[160:163], v[200:203], v[32:35]
    ds_read_b64_tr_b16 v[196:197], v218 offset:40960
    v_mfma_f32_16x16x32_bf16 v[36:39], v[164:167], v[200:203], v[36:39]
    ds_read_b64_tr_b16 v[198:199], v218 offset:41472
    v_mfma_f32_16x16x32_bf16 v[40:43], v[168:171], v[200:203], v[40:43]
    ds_read_b128 v[176:179], v213 offset:32768
    v_mfma_f32_16x16x32_bf16 v[44:47], v[172:175], v[200:203], v[44:47]
    s_add_u32 m0, s36, 65536
    s_nop 0
    buffer_load_dwordx4 v225, s[20:23], s41 offen lds
    s_add_u32 s41, s41, 458752
    v_mfma_f32_16x16x32_bf16 v[48:51], v[160:163], v[204:207], v[48:51]
    ds_read_b64_tr_b16 v[200:201], v219 offset:40960
    v_mfma_f32_16x16x32_bf16 v[52:55], v[164:167], v[204:207], v[52:55]
    ds_read_b64_tr_b16 v[202:203], v219 offset:41472
    v_mfma_f32_16x16x32_bf16 v[56:59], v[168:171], v[204:207], v[56:59]
    ds_read_b128 v[180:183], v213 offset:34816
    v_mfma_f32_16x16x32_bf16 v[60:63], v[172:175], v[204:207], v[60:63]
    s_add_u32 m0, s36, 73728
    s_nop 0
    buffer_load_dwordx4 v225, s[24:27], s42 offen lds
    s_add_u32 s42, s42, 458752
    s_waitcnt lgkmcnt(4)
    v_mfma_f32_16x16x32_bf16 v[64:67], v[160:163], v[208:211], v[64:67]
    ds_read_b64_tr_b16 v[204:205], v218 offset:49152
    v_mfma_f32_16x16x32_bf16 v[68:71], v[164:167], v[208:211], v[68:71]
    ds_read_b64_tr_b16 v[206:207], v218 offset:49664
    v_mfma_f32_16x16x32_bf16 v[72:75], v[168:171], v[208:211], v[72:75]
    ds_read_b128 v[184:187], v213 offset:36864
    v_mfma_f32_16x16x32_bf16 v[76:79], v[172:175], v[208:211], v[76:79]
    s_add_u32 m0, s36, 81920
    s_nop 0
    buffer_load_dwordx4 v224, s[16:19], s43 offen lds
    s_add_u32 s43, s43, 393216
    v_mfma_f32_16x16x32_bf16 v[80:83], v[160:163], v[192:195], v[80:83]
    ds_read_b64_tr_b16 v[208:209], v219 offset:49152
    v_mfma_f32_16x16x32_bf16 v[84:87], v[164:167], v[192:195], v[84:87]
    ds_read_b64_tr_b16 v[210:211], v219 offset:49664
    v_mfma_f32_16x16x32_bf16 v[88:91], v[168:171], v[192:195], v[88:91]
    ds_read_b128 v[188:191], v213 offset:38912
    v_mfma_f32_16x16x32_bf16 v[92:95], v[172:175], v[192:195], v[92:95]
    s_add_u32 m0, s36, 90112
    s_nop 0
    buffer_load_dwordx4 v224, s[16:19], s44 offen lds
    s_add_u32 s44, s44, 393216
    s_waitcnt lgkmcnt(4)
    v_mfma_f32_16x16x32_bf16 v[96:99], v[196:199], v[160:163], v[96:99]
    ds_read_b64_tr_b16 v[192:193], v218 offset:61440
    v_mfma_f32_16x16x32_bf16 v[100:103], v[196:199], v[164:167], v[100:103]
    ds_read_b64_tr_b16 v[194:195], v218 offset:61952
    v_mfma_f32_16x16x32_bf16 v[104:107], v[196:199], v[168:171], v[104:107]
    v_mfma_f32_16x16x32_bf16 v[108:111], v[196:199], v[172:175], v[108:111]
    s_add_u32 m0, s36, 98304
    s_nop 0
    buffer_load_dwordx4 v224, s[16:19], s45 offen lds
    s_add_u32 s45, s45, 393216
    v_mfma_f32_16x16x32_bf16 v[112:115], v[200:203], v[160:163], v[112:115]
    ds_read_b64_tr_b16 v[196:197], v219 offset:61440
    v_mfma_f32_16x16x32_bf16 v[116:119], v[200:203], v[164:167], v[116:119]
    ds_read_b64_tr_b16 v[198:199], v219 offset:61952
    v_mfma_f32_16x16x32_bf16 v[120:123], v[200:203], v[168:171], v[120:123]
    v_mfma_f32_16x16x32_bf16 v[124:127], v[200:203], v[172:175], v[124:127]
    buffer_load_dword v227, v226, s[32:35], s63 offen
    s_add_u32 s63, s63, s100
    s_waitcnt lgkmcnt(4)
    v_mfma_f32_16x16x32_bf16 v[128:131], v[204:207], v[160:163], v[128:131]
    ds_read_b64_tr_b16 v[200:201], v214 offset:45056
    v_mfma_f32_16x16x32_bf16 v[132:135], v[204:207], v[164:167], v[132:135]
    ds_read_b64_tr_b16 v[202:203], v214 offset:45568
    v_mfma_f32_16x16x32_bf16 v[136:139], v[204:207], v[168:171], v[136:139]
    v_mfma_f32_16x16x32_bf16 v[140:143], v[204:207], v[172:175], v[140:143]
    v_mfma_f32_16x16x32_bf16 v[144:147], v[208:211], v[160:163], v[144:147]
    ds_read_b64_tr_b16 v[204:205], v215 offset:45056
    v_mfma_f32_16x16x32_bf16 v[148:151], v[208:211], v[164:167], v[148:151]
    ds_read_b64_tr_b16 v[206:207], v215 offset:45568
    v_mfma_f32_16x16x32_bf16 v[152:155], v[208:211], v[168:171], v[152:155]
    v_mfma_f32_16x16x32_bf16 v[156:159], v[208:211], v[172:175], v[156:159]
    s_waitcnt lgkmcnt(4)
    v_mfma_f32_16x16x32_bf16 v[0:3], v[192:195], v[176:179], v[0:3]
    ds_read_b64_tr_b16 v[208:209], v216 offset:45056
    v_mfma_f32_16x16x32_bf16 v[4:7], v[192:195], v[180:183], v[4:7]
    ds_read_b64_tr_b16 v[210:211], v216 offset:45568
    v_mfma_f32_16x16x32_bf16 v[8:11], v[192:195], v[184:187], v[8:11]
    v_mfma_f32_16x16x32_bf16 v[12:15], v[192:195], v[188:191], v[12:15]
    v_mfma_f32_16x16x32_bf16 v[16:19], v[196:199], v[176:179], v[16:19]
    ds_read_b64_tr_b16 v[192:193], v217 offset:45056
    v_mfma_f32_16x16x32_bf16 v[20:23], v[196:199], v[180:183], v[20:23]
    ds_read_b64_tr_b16 v[194:195], v217 offset:45568
    v_mfma_f32_16x16x32_bf16 v[24:27], v[196:199], v[184:187], v[24:27]
    v_mfma_f32_16x16x32_bf16 v[28:31], v[196:199], v[188:191], v[28:31]
    s_waitcnt lgkmcnt(4)
    v_mfma_f32_16x16x32_bf16 v[32:35], v[176:179], v[200:203], v[32:35]
    ds_read_b64_tr_b16 v[196:197], v218 offset:45056
    v_mfma_f32_16x16x32_bf16 v[36:39], v[180:183], v[200:203], v[36:39]
    ds_read_b64_tr_b16 v[198:199], v218 offset:45568
    v_mfma_f32_16x16x32_bf16 v[40:43], v[184:187], v[200:203], v[40:43]
    v_mfma_f32_16x16x32_bf16 v[44:47], v[188:191], v[200:203], v[44:47]
    v_mfma_f32_16x16x32_bf16 v[48:51], v[176:179], v[204:207], v[48:51]
    ds_read_b64_tr_b16 v[200:201], v219 offset:45056
    v_mfma_f32_16x16x32_bf16 v[52:55], v[180:183], v[204:207], v[52:55]
    ds_read_b64_tr_b16 v[202:203], v219 offset:45568
    v_mfma_f32_16x16x32_bf16 v[56:59], v[184:187], v[204:207], v[56:59]
    v_mfma_f32_16x16x32_bf16 v[60:63], v[188:191], v[204:207], v[60:63]
    s_waitcnt lgkmcnt(4)
    v_mfma_f32_16x16x32_bf16 v[64:67], v[176:179], v[208:211], v[64:67]
    ds_read_b64_tr_b16 v[204:205], v218 offset:53248
    v_mfma_f32_16x16x32_bf16 v[68:71], v[180:183], v[208:211], v[68:71]
    ds_read_b64_tr_b16 v[206:207], v218 offset:53760
    v_mfma_f32_16x16x32_bf16 v[72:75], v[184:187], v[208:211], v[72:75]
    v_mfma_f32_16x16x32_bf16 v[76:79], v[188:191], v[208:211], v[76:79]
    v_mfma_f32_16x16x32_bf16 v[80:83], v[176:179], v[192:195], v[80:83]
    ds_read_b64_tr_b16 v[208:209], v219 offset:53248
    v_mfma_f32_16x16x32_bf16 v[84:87], v[180:183], v[192:195], v[84:87]
    ds_read_b64_tr_b16 v[210:211], v219 offset:53760
    v_mfma_f32_16x16x32_bf16 v[88:91], v[184:187], v[192:195], v[88:91]
    v_mfma_f32_16x16x32_bf16 v[92:95], v[188:191], v[192:195], v[92:95]
    s_waitcnt vmcnt(1) lgkmcnt(0)
    s_barrier
    v_mfma_f32_16x16x32_bf16 v[96:99], v[196:199], v[176:179], v[96:99]
    ds_read_b64_tr_b16 v[192:193], v218 offset:16384
    v_mfma_f32_16x16x32_bf16 v[100:103], v[196:199], v[180:183], v[100:103]
    ds_read_b64_tr_b16 v[194:195], v218 offset:16896
    v_mfma_f32_16x16x32_bf16 v[104:107], v[196:199], v[184:187], v[104:107]
    ds_read_b128 v[160:163], v212 offset:0
    v_mfma_f32_16x16x32_bf16 v[108:111], v[196:199], v[188:191], v[108:111]
    ds_read_b128 v[164:167], v212 offset:2048
    v_mfma_f32_16x16x32_bf16 v[112:115], v[200:203], v[176:179], v[112:115]
    ds_read_b64_tr_b16 v[196:197], v219 offset:16384
    v_mfma_f32_16x16x32_bf16 v[116:119], v[200:203], v[180:183], v[116:119]
    ds_read_b64_tr_b16 v[198:199], v219 offset:16896
    v_mfma_f32_16x16x32_bf16 v[120:123], v[200:203], v[184:187], v[120:123]
    ds_read_b128 v[168:171], v212 offset:4096
    v_mfma_f32_16x16x32_bf16 v[124:127], v[200:203], v[188:191], v[124:127]
    ds_read_b128 v[172:175], v212 offset:6144
    v_mfma_f32_16x16x32_bf16 v[128:131], v[204:207], v[176:179], v[128:131]
    ds_read_b64_tr_b16 v[200:201], v214 offset:0
    v_mfma_f32_16x16x32_bf16 v[132:135], v[204:207], v[180:183], v[132:135]
    ds_read_b64_tr_b16 v[202:203], v214 offset:512
    v_mfma_f32_16x16x32_bf16 v[136:139], v[204:207], v[184:187], v[136:139]
    v_mfma_f32_16x16x32_bf16 v[140:143], v[204:207], v[188:191], v[140:143]
    s_add_u32 m0, s36, 32768
    s_nop 0
    buffer_load_dwordx4 v220, s[12:15], s40 offen lds
    v_mfma_f32_16x16x32_bf16 v[144:147], v[208:211], v[176:179], v[144:147]
    ds_read_b64_tr_b16 v[204:205], v215 offset:0
    v_mfma_f32_16x16x32_bf16 v[148:151], v[208:211], v[180:183], v[148:151]
    ds_read_b64_tr_b16 v[206:207], v215 offset:512
    v_mfma_f32_16x16x32_bf16 v[152:155], v[208:211], v[184:187], v[152:155]
    v_mfma_f32_16x16x32_bf16 v[156:159], v[208:211], v[188:191], v[156:159]
    s_add_u32 m0, s36, 40960
    s_nop 0
    buffer_load_dwordx4 v221, s[12:15], s40 offen lds
    s_add_u32 s46, s46, 1
    s_branch L_p1_O_loop
L_p1_O_last:
    s_lshl_b32 s47, s37, 3
    s_and_b32 s48, s3, 6
    s_add_u32 s47, s47, s48
    s_cmp_lt_u32 s59, 32
    s_cselect_b32 s56, 0x3e8293ee, 1.0
    s_mov_b32 s57, s56
    s_lshl_b32 s48, s59, 17
    s_lshl_b32 s49, s47, 11
    s_add_u32 s48, s48, s49
    s_sub_u32 s50, s59, 32
    s_lshl_b32 s50, s50, 18
    s_lshl_b32 s49, s47, 12
    s_add_u32 s50, s50, s49
    s_add_u32 s50, s50, 4194304
    s_cmp_lt_u32 s59, 32
    s_cselect_b32 s41, s48, s50
    s_cselect_b32 s48, 1, 2
    s_lshl_b32 s48, s48, 11
    s_add_u32 s42, s41, s48
    s_lshl_b32 s43, s60, 18
    s_add_u32 s43, s43, s49
    s_add_u32 s43, s43, 4196352
    s_waitcnt lgkmcnt(4)
    v_mfma_f32_16x16x32_bf16 v[0:3], v[192:195], v[160:163], v[0:3]
    ds_read_b128 v[176:179], v213 offset:32768
    ds_read_b64_tr_b16 v[208:209], v218 offset:61440
    v_mfma_f32_16x16x32_bf16 v[4:7], v[192:195], v[164:167], v[4:7]
    ds_read_b128 v[180:183], v213 offset:34816
    ds_read_b64_tr_b16 v[210:211], v218 offset:61952
    v_mfma_f32_16x16x32_bf16 v[8:11], v[192:195], v[168:171], v[8:11]
    v_mfma_f32_16x16x32_bf16 v[12:15], v[192:195], v[172:175], v[12:15]
    v_mfma_f32_16x16x32_bf16 v[16:19], v[196:199], v[160:163], v[16:19]
    ds_read_b128 v[184:187], v213 offset:36864
    ds_read_b64_tr_b16 v[192:193], v219 offset:61440
    v_mfma_f32_16x16x32_bf16 v[20:23], v[196:199], v[164:167], v[20:23]
    ds_read_b128 v[188:191], v213 offset:38912
    ds_read_b64_tr_b16 v[194:195], v219 offset:61952
    v_mfma_f32_16x16x32_bf16 v[24:27], v[196:199], v[168:171], v[24:27]
    v_mfma_f32_16x16x32_bf16 v[28:31], v[196:199], v[172:175], v[28:31]
    s_waitcnt lgkmcnt(4)
    v_mfma_f32_16x16x32_bf16 v[32:35], v[160:163], v[200:203], v[32:35]
    ds_read_b64_tr_b16 v[196:197], v214 offset:45056
    v_mfma_f32_16x16x32_bf16 v[36:39], v[164:167], v[200:203], v[36:39]
    ds_read_b64_tr_b16 v[198:199], v214 offset:45568
    v_mfma_f32_16x16x32_bf16 v[40:43], v[168:171], v[200:203], v[40:43]
    v_mfma_f32_16x16x32_bf16 v[44:47], v[172:175], v[200:203], v[44:47]
    v_mfma_f32_16x16x32_bf16 v[48:51], v[160:163], v[204:207], v[48:51]
    ds_read_b64_tr_b16 v[200:201], v215 offset:45056
    v_mfma_f32_16x16x32_bf16 v[52:55], v[164:167], v[204:207], v[52:55]
    ds_read_b64_tr_b16 v[202:203], v215 offset:45568
    v_mfma_f32_16x16x32_bf16 v[56:59], v[168:171], v[204:207], v[56:59]
    v_mfma_f32_16x16x32_bf16 v[60:63], v[172:175], v[204:207], v[60:63]
    s_waitcnt lgkmcnt(4)
    v_mfma_f32_16x16x32_bf16 v[0:3], v[208:211], v[176:179], v[0:3]
    ds_read_b64_tr_b16 v[204:205], v216 offset:40960
    v_mfma_f32_16x16x32_bf16 v[4:7], v[208:211], v[180:183], v[4:7]
    ds_read_b64_tr_b16 v[206:207], v216 offset:41472
    v_mfma_f32_16x16x32_bf16 v[8:11], v[208:211], v[184:187], v[8:11]
    v_mfma_f32_16x16x32_bf16 v[12:15], v[208:211], v[188:191], v[12:15]
    v_mfma_f32_16x16x32_bf16 v[16:19], v[192:195], v[176:179], v[16:19]
    ds_read_b64_tr_b16 v[208:209], v216 offset:45056
    v_mfma_f32_16x16x32_bf16 v[20:23], v[192:195], v[180:183], v[20:23]
    ds_read_b64_tr_b16 v[210:211], v216 offset:45568
    v_mfma_f32_16x16x32_bf16 v[24:27], v[192:195], v[184:187], v[24:27]
    v_mfma_f32_16x16x32_bf16 v[28:31], v[192:195], v[188:191], v[28:31]
    s_waitcnt lgkmcnt(4)
    v_mfma_f32_16x16x32_bf16 v[32:35], v[176:179], v[196:199], v[32:35]
    ds_read_b64_tr_b16 v[192:193], v217 offset:40960
    v_mfma_f32_16x16x32_bf16 v[36:39], v[180:183], v[196:199], v[36:39]
    ds_read_b64_tr_b16 v[194:195], v217 offset:41472
    v_mfma_f32_16x16x32_bf16 v[40:43], v[184:187], v[196:199], v[40:43]
    v_mfma_f32_16x16x32_bf16 v[44:47], v[188:191], v[196:199], v[44:47]
    v_mfma_f32_16x16x32_bf16 v[48:51], v[176:179], v[200:203], v[48:51]
    ds_read_b64_tr_b16 v[196:197], v217 offset:45056
    v_mfma_f32_16x16x32_bf16 v[52:55], v[180:183], v[200:203], v[52:55]
    ds_read_b64_tr_b16 v[198:199], v217 offset:45568
    v_mfma_f32_16x16x32_bf16 v[56:59], v[184:187], v[200:203], v[56:59]
    v_mfma_f32_16x16x32_bf16 v[60:63], v[188:191], v[200:203], v[60:63]
    s_waitcnt lgkmcnt(4)
    v_mfma_f32_16x16x32_bf16 v[64:67], v[160:163], v[204:207], v[64:67]
    ds_read_b64_tr_b16 v[200:201], v218 offset:40960
    v_pk_mul_f32 v[0:1], v[0:1], s[56:57]
    v_pk_mul_f32 v[2:3], v[2:3], s[56:57]
    v_mfma_f32_16x16x32_bf16 v[68:71], v[164:167], v[204:207], v[68:71]
    ds_read_b64_tr_b16 v[202:203], v218 offset:41472
    v_pk_mul_f32 v[16:17], v[16:17], s[56:57]
    v_pk_mul_f32 v[18:19], v[18:19], s[56:57]
    v_mfma_f32_16x16x32_bf16 v[72:75], v[168:171], v[204:207], v[72:75]
    v_cvt_pk_bf16_f32 v0, v0, v1
    v_cvt_pk_bf16_f32 v1, v2, v3
    v_mfma_f32_16x16x32_bf16 v[76:79], v[172:175], v[204:207], v[76:79]
    v_cvt_pk_bf16_f32 v2, v16, v17
    v_cvt_pk_bf16_f32 v3, v18, v19
    v_mfma_f32_16x16x32_bf16 v[64:67], v[176:179], v[208:211], v[64:67]
    ds_read_b64_tr_b16 v[204:205], v218 offset:45056
    buffer_store_dwordx4 v[0:3], v230, s[4:7], s41 offen offset:0 sc1
    v_pk_mul_f32 v[4:5], v[4:5], s[56:57]
    v_mfma_f32_16x16x32_bf16 v[68:71], v[180:183], v[208:211], v[68:71]
    ds_read_b64_tr_b16 v[206:207], v218 offset:45568
    v_pk_mul_f32 v[6:7], v[6:7], s[56:57]
    v_pk_mul_f32 v[20:21], v[20:21], s[56:57]
    v_mfma_f32_16x16x32_bf16 v[72:75], v[184:187], v[208:211], v[72:75]
    v_pk_mul_f32 v[22:23], v[22:23], s[56:57]
    v_cvt_pk_bf16_f32 v4, v4, v5
    v_mfma_f32_16x16x32_bf16 v[76:79], v[188:191], v[208:211], v[76:79]
    v_cvt_pk_bf16_f32 v5, v6, v7
    v_cvt_pk_bf16_f32 v6, v20, v21
    s_waitcnt lgkmcnt(4)
    v_mfma_f32_16x16x32_bf16 v[80:83], v[160:163], v[192:195], v[80:83]
    ds_read_b64_tr_b16 v[208:209], v219 offset:40960
    v_cvt_pk_bf16_f32 v7, v22, v23
    buffer_store_dwordx4 v[4:7], v230, s[4:7], s41 offen offset:128 sc1
    v_mfma_f32_16x16x32_bf16 v[84:87], v[164:167], v[192:195], v[84:87]
    ds_read_b64_tr_b16 v[210:211], v219 offset:41472
    v_pk_mul_f32 v[8:9], v[8:9], s[56:57]
    v_pk_mul_f32 v[10:11], v[10:11], s[56:57]
    v_mfma_f32_16x16x32_bf16 v[88:91], v[168:171], v[192:195], v[88:91]
    v_pk_mul_f32 v[24:25], v[24:25], s[56:57]
    v_pk_mul_f32 v[26:27], v[26:27], s[56:57]
    v_mfma_f32_16x16x32_bf16 v[92:95], v[172:175], v[192:195], v[92:95]
    v_cvt_pk_bf16_f32 v8, v8, v9
    v_cvt_pk_bf16_f32 v9, v10, v11
    v_mfma_f32_16x16x32_bf16 v[80:83], v[176:179], v[196:199], v[80:83]
    ds_read_b64_tr_b16 v[192:193], v219 offset:45056
    v_cvt_pk_bf16_f32 v10, v24, v25
    v_cvt_pk_bf16_f32 v11, v26, v27
    v_mfma_f32_16x16x32_bf16 v[84:87], v[180:183], v[196:199], v[84:87]
    ds_read_b64_tr_b16 v[194:195], v219 offset:45568
    buffer_store_dwordx4 v[8:11], v230, s[4:7], s42 offen offset:0 sc1
    v_pk_mul_f32 v[12:13], v[12:13], s[56:57]
    v_mfma_f32_16x16x32_bf16 v[88:91], v[184:187], v[196:199], v[88:91]
    v_pk_mul_f32 v[14:15], v[14:15], s[56:57]
    v_pk_mul_f32 v[28:29], v[28:29], s[56:57]
    v_mfma_f32_16x16x32_bf16 v[92:95], v[188:191], v[196:199], v[92:95]
    v_pk_mul_f32 v[30:31], v[30:31], s[56:57]
    v_cvt_pk_bf16_f32 v12, v12, v13
    s_waitcnt lgkmcnt(4)
    v_mfma_f32_16x16x32_bf16 v[96:99], v[200:203], v[160:163], v[96:99]
    ds_read_b64_tr_b16 v[196:197], v218 offset:49152
    v_cvt_pk_bf16_f32 v13, v14, v15
    v_cvt_pk_bf16_f32 v14, v28, v29
    v_mfma_f32_16x16x32_bf16 v[100:103], v[200:203], v[164:167], v[100:103]
    ds_read_b64_tr_b16 v[198:199], v218 offset:49664
    v_cvt_pk_bf16_f32 v15, v30, v31
    buffer_store_dwordx4 v[12:15], v230, s[4:7], s42 offen offset:128 sc1
    v_mfma_f32_16x16x32_bf16 v[104:107], v[200:203], v[168:171], v[104:107]
    s_add_u32 s48, s43, 0
    v_cvt_pk_bf16_f32 v32, v32, v33
    v_mfma_f32_16x16x32_bf16 v[108:111], v[200:203], v[172:175], v[108:111]
    v_cvt_pk_bf16_f32 v33, v34, v35
    v_cvt_pk_bf16_f32 v34, v36, v37
    v_mfma_f32_16x16x32_bf16 v[96:99], v[204:207], v[176:179], v[96:99]
    ds_read_b64_tr_b16 v[200:201], v218 offset:53248
    v_cvt_pk_bf16_f32 v35, v38, v39
    buffer_store_dwordx4 v[32:35], v230, s[4:7], s48 offen offset:0 sc1
    v_mfma_f32_16x16x32_bf16 v[100:103], v[204:207], v[180:183], v[100:103]
    ds_read_b64_tr_b16 v[202:203], v218 offset:53760
    s_add_u32 s48, s43, 4096
    v_cvt_pk_bf16_f32 v40, v40, v41
    v_mfma_f32_16x16x32_bf16 v[104:107], v[204:207], v[184:187], v[104:107]
    v_cvt_pk_bf16_f32 v41, v42, v43
    v_cvt_pk_bf16_f32 v42, v44, v45
    v_mfma_f32_16x16x32_bf16 v[108:111], v[204:207], v[188:191], v[108:111]
    v_cvt_pk_bf16_f32 v43, v46, v47
    buffer_store_dwordx4 v[40:43], v230, s[4:7], s48 offen offset:0 sc1
    s_waitcnt lgkmcnt(4)
    v_mfma_f32_16x16x32_bf16 v[112:115], v[208:211], v[160:163], v[112:115]
    ds_read_b64_tr_b16 v[204:205], v219 offset:49152
    s_add_u32 s48, s43, 0
    v_cvt_pk_bf16_f32 v48, v48, v49
    v_mfma_f32_16x16x32_bf16 v[116:119], v[208:211], v[164:167], v[116:119]
    ds_read_b64_tr_b16 v[206:207], v219 offset:49664
    v_cvt_pk_bf16_f32 v49, v50, v51
    v_cvt_pk_bf16_f32 v50, v52, v53
    v_mfma_f32_16x16x32_bf16 v[120:123], v[208:211], v[168:171], v[120:123]
    v_cvt_pk_bf16_f32 v51, v54, v55
    buffer_store_dwordx4 v[48:51], v230, s[4:7], s48 offen offset:128 sc1
    v_mfma_f32_16x16x32_bf16 v[124:127], v[208:211], v[172:175], v[124:127]
    s_add_u32 s48, s43, 4096
    v_cvt_pk_bf16_f32 v56, v56, v57
    v_mfma_f32_16x16x32_bf16 v[112:115], v[192:195], v[176:179], v[112:115]
    ds_read_b64_tr_b16 v[208:209], v219 offset:53248
    v_cvt_pk_bf16_f32 v57, v58, v59
    v_cvt_pk_bf16_f32 v58, v60, v61
    v_mfma_f32_16x16x32_bf16 v[116:119], v[192:195], v[180:183], v[116:119]
    ds_read_b64_tr_b16 v[210:211], v219 offset:53760
    v_cvt_pk_bf16_f32 v59, v62, v63
    buffer_store_dwordx4 v[56:59], v230, s[4:7], s48 offen offset:128 sc1
    v_mfma_f32_16x16x32_bf16 v[120:123], v[192:195], v[184:187], v[120:123]
    s_add_u32 s48, s43, 262144
    v_cvt_pk_bf16_f32 v64, v64, v65
    v_mfma_f32_16x16x32_bf16 v[124:127], v[192:195], v[188:191], v[124:127]
    v_cvt_pk_bf16_f32 v65, v66, v67
    v_cvt_pk_bf16_f32 v66, v68, v69
    s_waitcnt lgkmcnt(4)
    v_mfma_f32_16x16x32_bf16 v[128:131], v[196:199], v[160:163], v[128:131]
    v_cvt_pk_bf16_f32 v67, v70, v71
    buffer_store_dwordx4 v[64:67], v230, s[4:7], s48 offen offset:0 sc1
    v_mfma_f32_16x16x32_bf16 v[132:135], v[196:199], v[164:167], v[132:135]
    s_add_u32 s48, s43, 266240
    v_cvt_pk_bf16_f32 v72, v72, v73
    v_mfma_f32_16x16x32_bf16 v[136:139], v[196:199], v[168:171], v[136:139]
    v_cvt_pk_bf16_f32 v73, v74, v75
    v_cvt_pk_bf16_f32 v74, v76, v77
    v_mfma_f32_16x16x32_bf16 v[140:143], v[196:199], v[172:175], v[140:143]
    v_cvt_pk_bf16_f32 v75, v78, v79
    buffer_store_dwordx4 v[72:75], v230, s[4:7], s48 offen offset:0 sc1
    v_mfma_f32_16x16x32_bf16 v[128:131], v[200:203], v[176:179], v[128:131]
    s_add_u32 s48, s43, 262144
    v_cvt_pk_bf16_f32 v80, v80, v81
    v_mfma_f32_16x16x32_bf16 v[132:135], v[200:203], v[180:183], v[132:135]
    v_cvt_pk_bf16_f32 v81, v82, v83
    v_cvt_pk_bf16_f32 v82, v84, v85
    v_mfma_f32_16x16x32_bf16 v[136:139], v[200:203], v[184:187], v[136:139]
    v_cvt_pk_bf16_f32 v83, v86, v87
    buffer_store_dwordx4 v[80:83], v230, s[4:7], s48 offen offset:128 sc1
    v_mfma_f32_16x16x32_bf16 v[140:143], v[200:203], v[188:191], v[140:143]
    s_add_u32 s48, s43, 266240
    v_cvt_pk_bf16_f32 v88, v88, v89
    s_waitcnt lgkmcnt(0)
    v_mfma_f32_16x16x32_bf16 v[144:147], v[204:207], v[160:163], v[144:147]
    v_cvt_pk_bf16_f32 v89, v90, v91
    v_cvt_pk_bf16_f32 v90, v92, v93
    v_mfma_f32_16x16x32_bf16 v[148:151], v[204:207], v[164:167], v[148:151]
    v_cvt_pk_bf16_f32 v91, v94, v95
    buffer_store_dwordx4 v[88:91], v230, s[4:7], s48 offen offset:128 sc1
    v_mfma_f32_16x16x32_bf16 v[152:155], v[204:207], v[168:171], v[152:155]
    v_mfma_f32_16x16x32_bf16 v[156:159], v[204:207], v[172:175], v[156:159]
    v_mfma_f32_16x16x32_bf16 v[144:147], v[208:211], v[176:179], v[144:147]
    v_mfma_f32_16x16x32_bf16 v[148:151], v[208:211], v[180:183], v[148:151]
    v_mfma_f32_16x16x32_bf16 v[152:155], v[208:211], v[184:187], v[152:155]
    v_mfma_f32_16x16x32_bf16 v[156:159], v[208:211], v[188:191], v[156:159]
    s_lshr_b32 s48, s47, 2
    s_mul_i32 s48, s48, 144
    s_add_u32 s48, s48, s58
    s_lshl_b32 s48, s48, 13
    s_and_b32 s49, s47, 2
    s_lshl_b32 s49, s49, 11
    s_add_u32 s48, s48, s49
    s_add_u32 s78, s48, 12582912
    s_mov_b32 s79, 0x7f000000
    s_waitcnt vmcnt(0)
    s_barrier
    s_cmp_lg_u32 s3, 0
    s_cbranch_scc1 L_p1_O_flag
    s_lshl_b32 s49, s2, 7
    s_add_u32 s49, s49, 31473664
    v_mov_b32 v248, 1
    v_mov_b32 v249, 0
    s_mov_b64 exec, 1
    buffer_store_dword v248, v249, s[4:7], s49 offen sc1
    s_mov_b64 exec, -1
L_p1_O_flag:
    v_pk_mul_f32 v[160:161], v[96:97], s[52:53]
    v_pk_mul_f32 v[162:163], v[98:99], s[52:53]
    v_pk_mul_f32 v[164:165], v[112:113], s[52:53]
    v_pk_mul_f32 v[166:167], v[114:115], s[52:53]
    v_pk_mul_f32 v[168:169], v[100:101], s[52:53]
    v_pk_mul_f32 v[170:171], v[102:103], s[52:53]
    v_pk_mul_f32 v[172:173], v[116:117], s[52:53]
    v_pk_mul_f32 v[174:175], v[118:119], s[52:53]
    v_exp_f32 v160, v160
    v_exp_f32 v161, v161
    v_exp_f32 v162, v162
    v_exp_f32 v163, v163
    v_exp_f32 v164, v164
    v_exp_f32 v165, v165
    v_exp_f32 v166, v166
    v_exp_f32 v167, v167
    v_exp_f32 v168, v168
    v_exp_f32 v169, v169
    v_exp_f32 v170, v170
    v_exp_f32 v171, v171
    v_exp_f32 v172, v172
    v_exp_f32 v173, v173
    v_exp_f32 v174, v174
    v_exp_f32 v175, v175
    v_pk_add_f32 v[160:161], v[160:161], s[54:55]
    v_pk_add_f32 v[162:163], v[162:163], s[54:55]
    v_pk_add_f32 v[164:165], v[164:165], s[54:55]
    v_pk_add_f32 v[166:167], v[166:167], s[54:55]
    v_pk_add_f32 v[168:169], v[168:169], s[54:55]
    v_pk_add_f32 v[170:171], v[170:171], s[54:55]
    v_pk_add_f32 v[172:173], v[172:173], s[54:55]
    v_pk_add_f32 v[174:175], v[174:175], s[54:55]
    v_rcp_f32 v160, v160
    v_rcp_f32 v161, v161
    v_rcp_f32 v162, v162
    v_rcp_f32 v163, v163
    v_rcp_f32 v164, v164
    v_rcp_f32 v165, v165
    v_rcp_f32 v166, v166
    v_rcp_f32 v167, v167
    v_rcp_f32 v168, v168
    v_rcp_f32 v169, v169
    v_rcp_f32 v170, v170
    v_rcp_f32 v171, v171
    v_rcp_f32 v172, v172
    v_rcp_f32 v173, v173
    v_rcp_f32 v174, v174
    v_rcp_f32 v175, v175
    v_pk_mul_f32 v[96:97], v[96:97], v[160:161]
    v_pk_mul_f32 v[98:99], v[98:99], v[162:163]
    v_pk_mul_f32 v[112:113], v[112:113], v[164:165]
    v_pk_mul_f32 v[114:115], v[114:115], v[166:167]
    v_pk_mul_f32 v[100:101], v[100:101], v[168:169]
    v_pk_mul_f32 v[102:103], v[102:103], v[170:171]
    v_pk_mul_f32 v[116:117], v[116:117], v[172:173]
    v_pk_mul_f32 v[118:119], v[118:119], v[174:175]
    v_pk_mul_f32 v[96:97], v[96:97], v[128:129]
    v_pk_mul_f32 v[98:99], v[98:99], v[130:131]
    v_pk_mul_f32 v[112:113], v[112:113], v[144:145]
    v_pk_mul_f32 v[114:115], v[114:115], v[146:147]
    v_pk_mul_f32 v[100:101], v[100:101], v[132:133]
    v_pk_mul_f32 v[102:103], v[102:103], v[134:135]
    v_pk_mul_f32 v[116:117], v[116:117], v[148:149]
    v_pk_mul_f32 v[118:119], v[118:119], v[150:151]
    v_cvt_pk_bf16_f32 v192, v96, v97
    v_cvt_pk_bf16_f32 v193, v98, v99
    v_cvt_pk_bf16_f32 v194, v112, v113
    v_cvt_pk_bf16_f32 v195, v114, v115
    v_cvt_pk_bf16_f32 v196, v100, v101
    v_cvt_pk_bf16_f32 v197, v102, v103
    v_cvt_pk_bf16_f32 v198, v116, v117
    v_cvt_pk_bf16_f32 v199, v118, v119
    v_pk_mul_f32 v[176:177], v[104:105], s[52:53]
    v_pk_mul_f32 v[178:179], v[106:107], s[52:53]
    v_pk_mul_f32 v[180:181], v[120:121], s[52:53]
    v_pk_mul_f32 v[182:183], v[122:123], s[52:53]
    v_pk_mul_f32 v[184:185], v[108:109], s[52:53]
    v_pk_mul_f32 v[186:187], v[110:111], s[52:53]
    v_pk_mul_f32 v[188:189], v[124:125], s[52:53]
    v_pk_mul_f32 v[190:191], v[126:127], s[52:53]
    v_exp_f32 v176, v176
    v_exp_f32 v177, v177
    v_exp_f32 v178, v178
    v_exp_f32 v179, v179
    v_exp_f32 v180, v180
    v_exp_f32 v181, v181
    v_exp_f32 v182, v182
    v_exp_f32 v183, v183
    v_exp_f32 v184, v184
    v_exp_f32 v185, v185
    v_exp_f32 v186, v186
    v_exp_f32 v187, v187
    v_exp_f32 v188, v188
    v_exp_f32 v189, v189
    v_exp_f32 v190, v190
    v_exp_f32 v191, v191
    v_pk_add_f32 v[176:177], v[176:177], s[54:55]
    v_pk_add_f32 v[178:179], v[178:179], s[54:55]
    v_pk_add_f32 v[180:181], v[180:181], s[54:55]
    v_pk_add_f32 v[182:183], v[182:183], s[54:55]
    v_pk_add_f32 v[184:185], v[184:185], s[54:55]
    v_pk_add_f32 v[186:187], v[186:187], s[54:55]
    v_pk_add_f32 v[188:189], v[188:189], s[54:55]
    v_pk_add_f32 v[190:191], v[190:191], s[54:55]
    v_rcp_f32 v176, v176
    v_rcp_f32 v177, v177
    v_rcp_f32 v178, v178
    v_rcp_f32 v179, v179
    v_rcp_f32 v180, v180
    v_rcp_f32 v181, v181
    v_rcp_f32 v182, v182
    v_rcp_f32 v183, v183
    v_rcp_f32 v184, v184
    v_rcp_f32 v185, v185
    v_rcp_f32 v186, v186
    v_rcp_f32 v187, v187
    v_rcp_f32 v188, v188
    v_rcp_f32 v189, v189
    v_rcp_f32 v190, v190
    v_rcp_f32 v191, v191
    v_pk_mul_f32 v[104:105], v[104:105], v[176:177]
    v_pk_mul_f32 v[106:107], v[106:107], v[178:179]
    v_pk_mul_f32 v[120:121], v[120:121], v[180:181]
    v_pk_mul_f32 v[122:123], v[122:123], v[182:183]
    v_pk_mul_f32 v[108:109], v[108:109], v[184:185]
    v_pk_mul_f32 v[110:111], v[110:111], v[186:187]
    v_pk_mul_f32 v[124:125], v[124:125], v[188:189]
    v_pk_mul_f32 v[126:127], v[126:127], v[190:191]
    v_pk_mul_f32 v[104:105], v[104:105], v[136:137]
    v_pk_mul_f32 v[106:107], v[106:107], v[138:139]
    v_pk_mul_f32 v[120:121], v[120:121], v[152:153]
    v_pk_mul_f32 v[122:123], v[122:123], v[154:155]
    v_pk_mul_f32 v[108:109], v[108:109], v[140:141]
    v_pk_mul_f32 v[110:111], v[110:111], v[142:143]
    v_pk_mul_f32 v[124:125], v[124:125], v[156:157]
    v_pk_mul_f32 v[126:127], v[126:127], v[158:159]
    v_cvt_pk_bf16_f32 v200, v104, v105
    v_cvt_pk_bf16_f32 v201, v106, v107
    v_cvt_pk_bf16_f32 v202, v120, v121
    v_cvt_pk_bf16_f32 v203, v122, v123
    v_cvt_pk_bf16_f32 v204, v108, v109
    v_cvt_pk_bf16_f32 v205, v110, v111
    v_cvt_pk_bf16_f32 v206, v124, v125
    v_cvt_pk_bf16_f32 v207, v126, v127
L_p1_gate:
    v_mov_b32 v250, 0
    v_lshlrev_b32 v248, 16, v232
    v_lshlrev_b32 v249, 16, v240
    v_mul_f32 v248, v248, v249
    v_and_b32 v232, 0xffff0000, v232
    v_and_b32 v240, 0xffff0000, v240
    v_mul_f32 v232, v232, v240
    v_cvt_pk_bf16_f32 v248, v248, v232
    v_lshlrev_b32 v249, 16, v248
    v_and_b32 v248, 0xffff0000, v248
    v_add_f32 v250, v250, v249
    v_add_f32 v250, v250, v248
    v_lshlrev_b32 v248, 16, v233
    v_lshlrev_b32 v249, 16, v241
    v_mul_f32 v248, v248, v249
    v_and_b32 v233, 0xffff0000, v233
    v_and_b32 v241, 0xffff0000, v241
    v_mul_f32 v233, v233, v241
    v_cvt_pk_bf16_f32 v248, v248, v233
    v_lshlrev_b32 v249, 16, v248
    v_and_b32 v248, 0xffff0000, v248
    v_add_f32 v250, v250, v249
    v_add_f32 v250, v250, v248
    v_lshlrev_b32 v248, 16, v234
    v_lshlrev_b32 v249, 16, v242
    v_mul_f32 v248, v248, v249
    v_and_b32 v234, 0xffff0000, v234
    v_and_b32 v242, 0xffff0000, v242
    v_mul_f32 v234, v234, v242
    v_cvt_pk_bf16_f32 v248, v248, v234
    v_lshlrev_b32 v249, 16, v248
    v_and_b32 v248, 0xffff0000, v248
    v_add_f32 v250, v250, v249
    v_add_f32 v250, v250, v248
    v_lshlrev_b32 v248, 16, v235
    v_lshlrev_b32 v249, 16, v243
    v_mul_f32 v248, v248, v249
    v_and_b32 v235, 0xffff0000, v235
    v_and_b32 v243, 0xffff0000, v243
    v_mul_f32 v235, v235, v243
    v_cvt_pk_bf16_f32 v248, v248, v235
    v_lshlrev_b32 v249, 16, v248
    v_and_b32 v248, 0xffff0000, v248
    v_add_f32 v250, v250, v249
    v_add_f32 v250, v250, v248
    v_lshlrev_b32 v248, 16, v236
    v_lshlrev_b32 v249, 16, v244
    v_mul_f32 v248, v248, v249
    v_and_b32 v236, 0xffff0000, v236
    v_and_b32 v244, 0xffff0000, v244
    v_mul_f32 v236, v236, v244
    v_cvt_pk_bf16_f32 v248, v248, v236
    v_lshlrev_b32 v249, 16, v248
    v_and_b32 v248, 0xffff0000, v248
    v_add_f32 v250, v250, v249
    v_add_f32 v250, v250, v248
    v_lshlrev_b32 v248, 16, v237
    v_lshlrev_b32 v249, 16, v245
    v_mul_f32 v248, v248, v249
    v_and_b32 v237, 0xffff0000, v237
    v_and_b32 v245, 0xffff0000, v245
    v_mul_f32 v237, v237, v245
    v_cvt_pk_bf16_f32 v248, v248, v237
    v_lshlrev_b32 v249, 16, v248
    v_and_b32 v248, 0xffff0000, v248
    v_add_f32 v250, v250, v249
    v_add_f32 v250, v250, v248
    v_lshlrev_b32 v248, 16, v238
    v_lshlrev_b32 v249, 16, v246
    v_mul_f32 v248, v248, v249
    v_and_b32 v238, 0xffff0000, v238
    v_and_b32 v246, 0xffff0000, v246
    v_mul_f32 v238, v238, v246
    v_cvt_pk_bf16_f32 v248, v248, v238
    v_lshlrev_b32 v249, 16, v248
    v_and_b32 v248, 0xffff0000, v248
    v_add_f32 v250, v250, v249
    v_add_f32 v250, v250, v248
    v_lshlrev_b32 v248, 16, v239
    v_lshlrev_b32 v249, 16, v247
    v_mul_f32 v248, v248, v249
    v_and_b32 v239, 0xffff0000, v239
    v_and_b32 v247, 0xffff0000, v247
    v_mul_f32 v239, v239, v247
    v_cvt_pk_bf16_f32 v248, v248, v239
    v_lshlrev_b32 v249, 16, v248
    v_and_b32 v248, 0xffff0000, v248
    v_add_f32 v250, v250, v249
    v_add_f32 v250, v250, v248
    s_nop 1
    v_add_f32_dpp v250, v250, v250 row_shr:1 bound_ctrl:0
    s_nop 1
    v_add_f32_dpp v250, v250, v250 row_shr:2 bound_ctrl:0
    s_nop 1
    v_add_f32_dpp v250, v250, v250 row_shr:4 bound_ctrl:0
    s_nop 1
    v_add_f32_dpp v250, v250, v250 row_shr:8 bound_ctrl:0
    s_nop 1
    v_add_f32_dpp v250, v250, v250 row_bcast:15 row_mask:0xa
    s_nop 1
    v_add_f32_dpp v250, v250, v250 row_bcast:31 row_mask:0xc
    v_cvt_pk_bf16_f32 v248, v250, v250
    v_and_b32 v248, 0xffff0000, v248
    v_mul_f32 v248, s52, v248
    v_exp_f32 v248, v248
    s_nop 0
    v_add_f32 v248, 1.0, v248
    v_rcp_f32 v248, v248
    s_nop 0
    v_cvt_pk_bf16_f32 v248, v248, v248
    v_and_b32 v248, 0xffff0000, v248
    v_sub_f32 v249, 1.0, v248
    v_cvt_pk_bf16_f32 v249, v249, v249
    v_and_b32 v249, 0xffff0000, v249
    s_lshl_b32 s48, s61, 3
    s_add_u32 s48, s48, 31457280
    v_mov_b32 v250, 0
    s_mov_b32 exec_lo, 0
    s_mov_b32 exec_hi, 0x80000000
    buffer_store_dwordx2 v[248:249], v250, s[4:7], s48 offen sc1
    s_mov_b64 exec, -1
    s_cmp_lt_u32 s3, 4
    s_cselect_b32 s29, 16, 48
    s_load_dwordx2 s[20:21], s[0:1], s29
    s_mov_b32 s22, 7340032
    s_cselect_b32 s22, 2097152, s22
    s_mov_b32 s23, 0x00020000
    s_load_dwordx2 s[16:17], s[0:1], 64
    s_and_b32 s29, s2, 7
    s_lshl_b32 s24, s29, 2
    s_lshr_b32 s30, s2, 3
    s_and_b32 s31, s30, 3
    s_add_u32 s24, s24, s31
    s_lshr_b32 s25, s2, 5
    s_lshl_b32 s36, s24, 2
    s_and_b32 s36, s36, 8
    s_add_u32 s36, s36, s29
    s_add_u32 s37, s36, 16
    s_add_u32 s38, s29, 24
    s_lshl_b32 s39, s25, 5
    s_add_u32 s36, s36, s39
    s_lshr_b32 s40, s29, 1
    s_lshl_b32 s40, s40, 2
    s_add_u32 s40, s40, s31
    s_and_b32 s41, s29, 1
    s_lshl_b32 s41, s41, 3
    s_add_u32 s41, s41, s25
    s_and_b32 s42, s3, 3
    s_cmp_lt_u32 s3, 4
    s_cselect_b32 s30, 112, 0
    s_cselect_b32 s45, 4, 14
    s_cselect_b32 s46, 0, 4
    s_add_u32 s30, s30, s42
    s_mul_i32 s43, s40, 144
    s_add_u32 s43, s43, s30
    s_lshl_b32 s43, s43, 13
    s_add_u32 s43, s43, 12582912
    s_lshl_b32 s44, s42, 16
    s_lshl_b32 s30, s41, 7
    s_add_u32 s44, s44, s30
    s_lshl_b32 s48, s42, 13
    s_add_u32 s30, s48, 49152
    s_cmp_lt_u32 s3, 4
    s_cselect_b32 s48, s30, s48
    v_lshrrev_b32 v248, 3, v228
    v_and_b32 v249, 6, v248
    v_and_b32 v250, 7, v228
    v_xor_b32 v249, v249, v250
    v_lshlrev_b32 v249, 4, v249
    v_lshlrev_b32 v248, 11, v248
    v_add_u32 v233, v248, v249
    v_lshrrev_b32 v248, 2, v228
    v_lshlrev_b32 v248, 7, v248
    v_lshlrev_b32 v249, 2, v228
    v_and_b32 v249, 0x60, v249
    v_add_u32 v248, v248, v249
    v_and_b32 v249, 3, v228
    v_lshlrev_b32 v249, 3, v249
    v_add_u32 v248, v248, v249
    v_add_u32 v234, s48, v248
    v_xor_b32 v235, 32, v234
    v_xor_b32 v236, 64, v234
    v_xor_b32 v237, 96, v234
    s_lshl_b32 s30, s40, 10
    s_add_u32 s46, s46, s30
    s_add_u32 s46, s46, 31457280
    v_add_u32 v232, 4096, v229
    s_mov_b32 s18, 4194304
    s_mov_b32 s19, 0x00020000
    s_lshl_b32 s33, s24, 18
    s_add_u32 s33, s33, 4194304
    s_lshl_b32 s27, s42, 13
    s_add_u32 s26, s33, s27
    s_add_u32 s27, s27, 49152
    s_mov_b32 s12, s4
    s_mov_b32 s13, s5
    s_mov_b32 s14, 31506432
    s_mov_b32 s15, 0x00020000
    s_add_u32 s14, s33, 262144
    s_lshl_b32 s30, s42, 13
    v_add_u32 v253, s30, v229
    s_cmp_lt_u32 s3, 4
    s_cbranch_scc0 L_g_start
    ds_write_b128 v253, v[192:195] offset:0
    ds_write_b128 v253, v[196:199] offset:1024
    ds_write_b128 v253, v[200:203] offset:2048
    ds_write_b128 v253, v[204:207] offset:3072
    ds_write_b128 v253, v[208:211] offset:4096
    ds_write_b128 v253, v[212:215] offset:5120
    ds_write_b128 v253, v[216:219] offset:6144
    ds_write_b128 v253, v[220:223] offset:7168
    v_mov_b32 v24, 147456
    s_lshl_b32 s32, s25, 3
    s_lshl_b32 s30, s3, 1
    s_add_u32 s32, s32, s30
    v_and_b32 v248, 7, v228
    v_lshrrev_b32 v249, 1, v228
    v_and_b32 v249, 8, v249
    v_or_b32 v248, v248, v249
    v_lshrrev_b32 v249, 3, v228
    v_and_b32 v249, 1, v249
    v_lshlrev_b32 v20, 10, v249
    v_lshlrev_b32 v248, 4, v248
    v_add_u32 v20, v20, v248
    v_lshrrev_b32 v248, 5, v228
    v_lshlrev_b32 v248, 8, v248
    v_add_u32 v20, v20, v248
    v_and_b32 v248, 4, v228
    v_cmp_eq_u32 vcc, 0, v248
    v_mov_b32 v249, 0x3f803f80
    s_nop 1
    v_cndmask_b32 v16, 0, v249, vcc
    v_mov_b32 v17, v16
    v_xor_b32 v18, v249, v16
    v_mov_b32 v19, v18
    v_and_b32 v248, 1, v228
    v_cmp_eq_u32 vcc, 0, v248
    v_mov_b32 v248, 0xeeeeeeee
    v_mov_b32 v249, 0x44444444
    v_cndmask_b32 v26, v248, v249, vcc
    s_waitcnt lgkmcnt(0)
    s_lshl_b32 s30, s3, 2
    s_add_u32 s30, s30, 147520
    v_mov_b32 v248, s30
    v_mov_b32 v249, 1
    ds_write_b32 v248, v249
    v_mov_b64 v[88:89], 0
    v_mov_b64 v[90:91], 0
    v_mov_b64 v[92:93], 0
    v_mov_b64 v[94:95], 0
    v_mov_b64 v[96:97], 0
    v_mov_b64 v[98:99], 0
    v_mov_b64 v[100:101], 0
    v_mov_b64 v[102:103], 0
    v_mov_b64 v[112:113], 0
    v_mov_b64 v[108:109], 0
    v_mov_b64 v[114:115], 0
    v_mov_b64 v[110:111], 0
    v_mov_b64 v[176:177], 0
    v_mov_b64 v[178:179], 0
    v_mov_b64 v[180:181], 0
    v_mov_b64 v[182:183], 0
    v_mov_b64 v[184:185], 0
    v_mov_b64 v[186:187], 0
    v_mov_b64 v[188:189], 0
    v_mov_b64 v[190:191], 0
    v_mov_b64 v[200:201], 0
    v_mov_b64 v[196:197], 0
    v_mov_b64 v[202:203], 0
    v_mov_b64 v[198:199], 0
    v_mov_b64 v[12:13], 0
    v_mov_b64 v[14:15], 0
    v_add_u32 v21, 49152, v229
    v_mov_b32 v22, v21
    s_mov_b32 s47, 49152
    s_lshl_b32 s30, s3, 2
    s_add_u32 s30, s30, 147456
    v_mov_b32 v25, s30
    v_mov_b32 v23, 0
    s_mov_b32 s34, 0x5d800000
    s_mov_b32 s35, 0
    s_lshl_b32 s29, s24, 17
    s_lshl_b32 s30, s32, 11
    s_add_u32 s29, s29, s30
    s_cmp_lg_u32 s3, 0
    s_cbranch_scc1 L_p2_polled
    v_and_b32 v248, 7, v228
    v_lshlrev_b32 v248, 5, v248
    v_add_u32 v249, s37, v248
    v_add_u32 v250, s38, v248
    v_mov_b32 v252, s36
    v_cmp_gt_u32 vcc, 16, v228
    s_nop 1
    v_cndmask_b32 v252, v252, v250, vcc
    v_cmp_gt_u32 vcc, 8, v228
    s_nop 1
    v_cndmask_b32 v252, v252, v249, vcc
    v_lshlrev_b32 v252, 7, v252
    v_add_u32 v252, 31473664, v252
    v_mov_b32 v248, 0
    v_mov_b32 v249, 0x100
    s_mov_b32 s35, 0
L_p2_c0:
    v_cmp_gt_u32 vcc, v249, v251
    s_cmp_eq_u64 vcc, 0
    s_cbranch_scc1 L_p2_c0_ok
    s_sleep 1
    buffer_load_dword v251, v248, s[8:11], 0 offen sc1
    s_waitcnt vmcnt(0)
    s_add_u32 s35, s35, 1
    s_cmp_lt_u32 s35, 262144
    s_cbranch_scc1 L_p2_c0
L_p2_c0_ok:
    buffer_load_dword v250, v252, s[4:7], 0 offen sc1
    s_waitcnt vmcnt(0)
    s_mov_b32 s35, 0
L_p2_fl:
    v_cmp_ne_u32 vcc, 1, v250
    s_cmp_eq_u64 vcc, 0
    s_cbranch_scc1 L_p2_fl_ok
    s_sleep 1
    buffer_load_dword v250, v252, s[4:7], 0 offen sc1
    s_waitcnt vmcnt(0)
    s_add_u32 s35, s35, 1
    s_cmp_lt_u32 s35, 262144
    s_cbranch_scc1 L_p2_fl
L_p2_fl_ok:
    v_mov_b32 v248, 147500
    v_mov_b32 v249, 1
    ds_write_b32 v248, v249
L_p2_polled:
    v_mov_b32 v248, 147500
    s_mov_b32 s35, 0
L_a_fl:
    ds_read_b32 v249, v248
    s_waitcnt lgkmcnt(0)
    v_cmp_gt_u32 vcc, 1, v249
    s_cmp_eq_u64 vcc, 0
    s_cbranch_scc1 L_a_fl_ok
    s_sleep 2
    s_add_u32 s35, s35, 1
    s_cmp_lt_u32 s35, 2097152
    s_cbranch_scc1 L_a_fl
L_a_fl_ok:
    s_mov_b32 s35, 0
    s_setprio 2
    buffer_load_dwordx4 v[32:35], v229, s[4:7], s29 offen offset:0 sc1
    buffer_load_dwordx4 v[36:39], v229, s[4:7], s29 offen offset:1024 sc1
    buffer_load_dwordx4 v[120:123], v229, s[4:7], s29 offen offset:2048 sc1
    buffer_load_dwordx4 v[124:127], v229, s[4:7], s29 offen offset:3072 sc1
    s_add_u32 m0, s27, 0
    s_add_u32 s30, s26, 0
    buffer_load_dwordx4 v229, s[12:15], s30 offen sc1 lds
    buffer_load_dwordx4 v229, s[12:15], s30 offen offset:1024 sc1 lds
    buffer_load_dwordx4 v229, s[12:15], s30 offen offset:2048 sc1 lds
    buffer_load_dwordx4 v229, s[12:15], s30 offen offset:3072 sc1 lds
    s_add_u32 m0, s27, 4096
    s_add_u32 s30, s26, 4096
    buffer_load_dwordx4 v229, s[12:15], s30 offen sc1 lds
    buffer_load_dwordx4 v229, s[12:15], s30 offen offset:1024 sc1 lds
    buffer_load_dwordx4 v229, s[12:15], s30 offen offset:2048 sc1 lds
    buffer_load_dwordx4 v229, s[12:15], s30 offen offset:3072 sc1 lds
    s_add_u32 s26, s26, 32768
    s_add_u32 s27, s27, 32768
    s_sub_u32 s30, s27, 98304
    s_cmp_ge_u32 s27, 147456
    s_cselect_b32 s27, s30, s27
    s_waitcnt vmcnt(0)
    v_mov_b32 v248, 147504
    v_mov_b32 v249, 1
    s_mov_b64 exec, 1
    ds_add_rtn_u32 v249, v248, v249
    s_waitcnt lgkmcnt(0)
    v_readfirstlane_b32 s80, v249
    s_mov_b64 exec, -1
    s_cmp_eq_u32 s80, 3
    s_cbranch_scc0 L_a_d0
L_a_d0:
    s_add_u32 m0, s27, 0
    s_add_u32 s30, s26, 0
    buffer_load_dwordx4 v229, s[12:15], s30 offen sc1 lds
    buffer_load_dwordx4 v229, s[12:15], s30 offen offset:1024 sc1 lds
    buffer_load_dwordx4 v229, s[12:15], s30 offen offset:2048 sc1 lds
    buffer_load_dwordx4 v229, s[12:15], s30 offen offset:3072 sc1 lds
    s_add_u32 m0, s27, 4096
    s_add_u32 s30, s26, 4096
    buffer_load_dwordx4 v229, s[12:15], s30 offen sc1 lds
    buffer_load_dwordx4 v229, s[12:15], s30 offen offset:1024 sc1 lds
    buffer_load_dwordx4 v229, s[12:15], s30 offen offset:2048 sc1 lds
    buffer_load_dwordx4 v229, s[12:15], s30 offen offset:3072 sc1 lds
    s_add_u32 s26, s26, 32768
    s_add_u32 s27, s27, 32768
    s_sub_u32 s30, s27, 98304
    s_cmp_ge_u32 s27, 147456
    s_cselect_b32 s27, s30, s27
    v_mov_b32 v248, 147504
    s_mov_b32 s35, 0
L_a_dw:
    ds_read_b32 v249, v248
    s_waitcnt lgkmcnt(0)
    v_cmp_gt_u32 vcc, 4, v249
    s_cmp_eq_u64 vcc, 0
    s_cbranch_scc1 L_a_dw_ok
    s_sleep 2
    s_add_u32 s35, s35, 1
    s_cmp_lt_u32 s35, 2097152
    s_cbranch_scc1 L_a_dw
L_a_dw_ok:
    s_mov_b32 s35, 0
    ds_read_b128 v[0:3], v21 offset:0
    ds_read_b128 v[4:7], v21 offset:1024
    s_waitcnt lgkmcnt(0)
    v_mfma_f32_32x32x16_bf16 v[40:55], v[0:3], v[32:35], 0
    v_mfma_f32_32x32x16_bf16 v[40:55], v[4:7], v[36:39], v[40:55]
    v_mfma_f32_32x32x16_bf16 v[128:143], v[0:3], v[120:123], 0
    v_mfma_f32_32x32x16_bf16 v[128:143], v[4:7], v[124:127], v[128:143]
    ds_read_b128 v[0:3], v21 offset:4096
    ds_read_b128 v[4:7], v21 offset:5120
    ds_read_b128 v[8:11], v22 offset:2048
    s_nop 14
    v_max3_f32 v116, v40, v41, v42
    v_max3_f32 v116, v116, v43, v44
    v_max3_f32 v116, v116, v45, v46
    v_max3_f32 v116, v116, v47, v48
    v_max3_f32 v116, v116, v49, v50
    v_max3_f32 v116, v116, v51, v52
    v_max3_f32 v116, v116, v53, v54
    v_max_f32 v116, v116, v55
    v_mov_b32 v117, v116
    s_nop 1
    v_permlane32_swap_b32 v117, v116
    s_nop 1
    v_max_f32 v116, v116, v117
    v_sub_f32 v72, 0, v116
    v_sub_f32 v73, 0, v116
    v_sub_f32 v74, 0, v116
    v_sub_f32 v75, 0, v116
    v_sub_f32 v76, 0, v116
    v_sub_f32 v77, 0, v116
    v_sub_f32 v78, 0, v116
    v_sub_f32 v79, 0, v116
    v_sub_f32 v80, 0, v116
    v_sub_f32 v81, 0, v116
    v_sub_f32 v82, 0, v116
    v_sub_f32 v83, 0, v116
    v_sub_f32 v84, 0, v116
    v_sub_f32 v85, 0, v116
    v_sub_f32 v86, 0, v116
    v_sub_f32 v87, 0, v116
    v_sub_f32 v40, v40, v116
    v_sub_f32 v41, v41, v116
    v_sub_f32 v42, v42, v116
    v_sub_f32 v43, v43, v116
    v_sub_f32 v44, v44, v116
    v_sub_f32 v45, v45, v116
    v_sub_f32 v46, v46, v116
    v_sub_f32 v47, v47, v116
    v_sub_f32 v48, v48, v116
    v_sub_f32 v49, v49, v116
    v_sub_f32 v50, v50, v116
    v_sub_f32 v51, v51, v116
    v_sub_f32 v52, v52, v116
    v_sub_f32 v53, v53, v116
    v_sub_f32 v54, v54, v116
    v_sub_f32 v55, v55, v116
    v_max3_f32 v204, v128, v129, v130
    v_max3_f32 v204, v204, v131, v132
    v_max3_f32 v204, v204, v133, v134
    v_max3_f32 v204, v204, v135, v136
    v_max3_f32 v204, v204, v137, v138
    v_max3_f32 v204, v204, v139, v140
    v_max3_f32 v204, v204, v141, v142
    v_max_f32 v204, v204, v143
    v_mov_b32 v205, v204
    s_nop 1
    v_permlane32_swap_b32 v205, v204
    s_nop 1
    v_max_f32 v204, v204, v205
    v_sub_f32 v160, 0, v204
    v_sub_f32 v161, 0, v204
    v_sub_f32 v162, 0, v204
    v_sub_f32 v163, 0, v204
    v_sub_f32 v164, 0, v204
    v_sub_f32 v165, 0, v204
    v_sub_f32 v166, 0, v204
    v_sub_f32 v167, 0, v204
    v_sub_f32 v168, 0, v204
    v_sub_f32 v169, 0, v204
    v_sub_f32 v170, 0, v204
    v_sub_f32 v171, 0, v204
    v_sub_f32 v172, 0, v204
    v_sub_f32 v173, 0, v204
    v_sub_f32 v174, 0, v204
    v_sub_f32 v175, 0, v204
    v_sub_f32 v128, v128, v204
    v_sub_f32 v129, v129, v204
    v_sub_f32 v130, v130, v204
    v_sub_f32 v131, v131, v204
    v_sub_f32 v132, v132, v204
    v_sub_f32 v133, v133, v204
    v_sub_f32 v134, v134, v204
    v_sub_f32 v135, v135, v204
    v_sub_f32 v136, v136, v204
    v_sub_f32 v137, v137, v204
    v_sub_f32 v138, v138, v204
    v_sub_f32 v139, v139, v204
    v_sub_f32 v140, v140, v204
    v_sub_f32 v141, v141, v204
    v_sub_f32 v142, v142, v204
    v_sub_f32 v143, v143, v204
    s_mov_b32 s28, 0
.p2align 6
L_p2_loop:
    s_waitcnt lgkmcnt(1)
    v_mfma_f32_32x32x16_bf16 v[56:71], v[0:3], v[32:35], v[72:87]
    v_exp_f32 v40, v40
    v_exp_f32 v41, v41
    v_exp_f32 v42, v42
    v_mfma_f32_32x32x16_bf16 v[56:71], v[4:7], v[36:39], v[56:71]
    v_exp_f32 v43, v43
    v_exp_f32 v44, v44
    v_exp_f32 v45, v45
    v_mfma_f32_32x32x16_bf16 v[88:103], v[12:15], v[108:111], v[88:103]
    v_exp_f32 v46, v46
    v_exp_f32 v47, v47
    v_cvt_pk_bf16_f32 v104, v40, v41
    v_cvt_pk_bf16_f32 v105, v42, v43
    v_cvt_pk_bf16_f32 v106, v44, v45
    v_cvt_pk_bf16_f32 v107, v46, v47
    v_exp_f32 v48, v48
    v_exp_f32 v49, v49
    s_waitcnt lgkmcnt(0)
    v_mfma_f32_32x32x16_bf16 v[88:103], v[8:11], v[104:107], v[88:103]
    v_exp_f32 v50, v50
    v_exp_f32 v51, v51
    v_exp_f32 v52, v52
    v_smfmac_f32_16x16x64_bf16 v[112:115], v[16:19], v[104:111], v26
    v_exp_f32 v53, v53
    v_exp_f32 v54, v54
    v_exp_f32 v55, v55
    v_cvt_pk_bf16_f32 v108, v48, v49
    v_cvt_pk_bf16_f32 v109, v50, v51
    v_cvt_pk_bf16_f32 v110, v52, v53
    v_cvt_pk_bf16_f32 v111, v54, v55
    v_mfma_f32_32x32x16_bf16 v[144:159], v[0:3], v[120:123], v[160:175]
    ds_read_b128 v[0:3], v21 offset:8192
    v_exp_f32 v128, v128
    v_exp_f32 v129, v129
    v_exp_f32 v130, v130
    v_mfma_f32_32x32x16_bf16 v[144:159], v[4:7], v[124:127], v[144:159]
    ds_read_b128 v[4:7], v21 offset:9216
    v_exp_f32 v131, v131
    v_exp_f32 v132, v132
    v_exp_f32 v133, v133
    v_mfma_f32_32x32x16_bf16 v[176:191], v[12:15], v[196:199], v[176:191]
    ds_read_b128 v[12:15], v22 offset:3072
    v_exp_f32 v134, v134
    v_exp_f32 v135, v135
    v_cvt_pk_bf16_f32 v192, v128, v129
    v_cvt_pk_bf16_f32 v193, v130, v131
    v_cvt_pk_bf16_f32 v194, v132, v133
    v_cvt_pk_bf16_f32 v195, v134, v135
    v_exp_f32 v136, v136
    v_exp_f32 v137, v137
    v_mfma_f32_32x32x16_bf16 v[176:191], v[8:11], v[192:195], v[176:191]
    ds_read_b128 v[8:11], v22 offset:6144
    v_exp_f32 v138, v138
    v_exp_f32 v139, v139
    v_exp_f32 v140, v140
    v_smfmac_f32_16x16x64_bf16 v[200:203], v[16:19], v[192:199], v26
    v_exp_f32 v141, v141
    v_exp_f32 v142, v142
    v_exp_f32 v143, v143
    v_cvt_pk_bf16_f32 v196, v136, v137
    v_cvt_pk_bf16_f32 v197, v138, v139
    v_cvt_pk_bf16_f32 v198, v140, v141
    v_cvt_pk_bf16_f32 v199, v142, v143
    s_waitcnt lgkmcnt(1)
    v_mfma_f32_32x32x16_bf16 v[40:55], v[0:3], v[32:35], v[72:87]
    v_exp_f32 v56, v56
    v_exp_f32 v57, v57
    v_exp_f32 v58, v58
    v_mfma_f32_32x32x16_bf16 v[40:55], v[4:7], v[36:39], v[40:55]
    v_exp_f32 v59, v59
    v_exp_f32 v60, v60
    v_exp_f32 v61, v61
    v_mfma_f32_32x32x16_bf16 v[88:103], v[12:15], v[108:111], v[88:103]
    v_exp_f32 v62, v62
    v_exp_f32 v63, v63
    v_cvt_pk_bf16_f32 v104, v56, v57
    v_cvt_pk_bf16_f32 v105, v58, v59
    v_cvt_pk_bf16_f32 v106, v60, v61
    v_cvt_pk_bf16_f32 v107, v62, v63
    v_exp_f32 v64, v64
    v_exp_f32 v65, v65
    s_waitcnt lgkmcnt(0)
    v_mfma_f32_32x32x16_bf16 v[88:103], v[8:11], v[104:107], v[88:103]
    v_add_u32 v23, 1, v23
    s_waitcnt vmcnt(0)
    ds_write_b32 v25, v23
    v_exp_f32 v66, v66
    v_exp_f32 v67, v67
    v_exp_f32 v68, v68
    v_smfmac_f32_16x16x64_bf16 v[112:115], v[16:19], v[104:111], v26
    v_exp_f32 v69, v69
    v_exp_f32 v70, v70
    v_exp_f32 v71, v71
    v_cvt_pk_bf16_f32 v108, v64, v65
    v_cvt_pk_bf16_f32 v109, v66, v67
    v_cvt_pk_bf16_f32 v110, v68, v69
    v_cvt_pk_bf16_f32 v111, v70, v71
    v_mfma_f32_32x32x16_bf16 v[128:143], v[0:3], v[120:123], v[160:175]
    ds_read_b128 v[0:3], v21 offset:12288
    v_exp_f32 v144, v144
    v_exp_f32 v145, v145
    v_exp_f32 v146, v146
    v_mfma_f32_32x32x16_bf16 v[128:143], v[4:7], v[124:127], v[128:143]
    ds_read_b128 v[4:7], v21 offset:13312
    v_exp_f32 v147, v147
    v_exp_f32 v148, v148
    v_exp_f32 v149, v149
    v_mfma_f32_32x32x16_bf16 v[176:191], v[12:15], v[196:199], v[176:191]
    ds_read_b128 v[12:15], v22 offset:7168
    v_exp_f32 v150, v150
    v_exp_f32 v151, v151
    v_cvt_pk_bf16_f32 v192, v144, v145
    v_cvt_pk_bf16_f32 v193, v146, v147
    v_cvt_pk_bf16_f32 v194, v148, v149
    v_cvt_pk_bf16_f32 v195, v150, v151
    v_exp_f32 v152, v152
    v_exp_f32 v153, v153
    v_mfma_f32_32x32x16_bf16 v[176:191], v[8:11], v[192:195], v[176:191]
    ds_read_b128 v[8:11], v22 offset:10240
    v_exp_f32 v154, v154
    v_exp_f32 v155, v155
    v_exp_f32 v156, v156
    v_smfmac_f32_16x16x64_bf16 v[200:203], v[16:19], v[192:199], v26
    v_exp_f32 v157, v157
    v_exp_f32 v158, v158
    v_exp_f32 v159, v159
    v_cvt_pk_bf16_f32 v196, v152, v153
    v_cvt_pk_bf16_f32 v197, v154, v155
    v_cvt_pk_bf16_f32 v198, v156, v157
    v_cvt_pk_bf16_f32 v199, v158, v159
    s_waitcnt lgkmcnt(1)
    v_mfma_f32_32x32x16_bf16 v[56:71], v[0:3], v[32:35], v[72:87]
    v_exp_f32 v40, v40
    v_exp_f32 v41, v41
    v_exp_f32 v42, v42
    v_mfma_f32_32x32x16_bf16 v[56:71], v[4:7], v[36:39], v[56:71]
    v_exp_f32 v43, v43
    v_exp_f32 v44, v44
    v_exp_f32 v45, v45
    v_mfma_f32_32x32x16_bf16 v[88:103], v[12:15], v[108:111], v[88:103]
    v_exp_f32 v46, v46
    v_exp_f32 v47, v47
    v_cvt_pk_bf16_f32 v104, v40, v41
    v_cvt_pk_bf16_f32 v105, v42, v43
    v_cvt_pk_bf16_f32 v106, v44, v45
    v_cvt_pk_bf16_f32 v107, v46, v47
    v_exp_f32 v48, v48
    v_exp_f32 v49, v49
    s_waitcnt lgkmcnt(0)
    v_mfma_f32_32x32x16_bf16 v[88:103], v[8:11], v[104:107], v[88:103]
    v_exp_f32 v50, v50
    v_exp_f32 v51, v51
    v_exp_f32 v52, v52
    v_smfmac_f32_16x16x64_bf16 v[112:115], v[16:19], v[104:111], v26
    v_exp_f32 v53, v53
    v_exp_f32 v54, v54
    v_exp_f32 v55, v55
    v_cvt_pk_bf16_f32 v108, v48, v49
    v_cvt_pk_bf16_f32 v109, v50, v51
    v_cvt_pk_bf16_f32 v110, v52, v53
    v_cvt_pk_bf16_f32 v111, v54, v55
    v_mfma_f32_32x32x16_bf16 v[144:159], v[0:3], v[120:123], v[160:175]
    ds_read_b128 v[0:3], v21 offset:16384
    v_exp_f32 v128, v128
    v_exp_f32 v129, v129
    v_exp_f32 v130, v130
    v_mfma_f32_32x32x16_bf16 v[144:159], v[4:7], v[124:127], v[144:159]
    ds_read_b128 v[4:7], v21 offset:17408
    v_exp_f32 v131, v131
    v_exp_f32 v132, v132
    v_exp_f32 v133, v133
    v_mfma_f32_32x32x16_bf16 v[176:191], v[12:15], v[196:199], v[176:191]
    ds_read_b128 v[12:15], v22 offset:11264
    v_exp_f32 v134, v134
    v_exp_f32 v135, v135
    v_cvt_pk_bf16_f32 v192, v128, v129
    v_cvt_pk_bf16_f32 v193, v130, v131
    v_cvt_pk_bf16_f32 v194, v132, v133
    v_cvt_pk_bf16_f32 v195, v134, v135
    v_exp_f32 v136, v136
    v_exp_f32 v137, v137
    v_mfma_f32_32x32x16_bf16 v[176:191], v[8:11], v[192:195], v[176:191]
    ds_read_b128 v[8:11], v22 offset:14336
    v_exp_f32 v138, v138
    v_exp_f32 v139, v139
    v_exp_f32 v140, v140
    v_smfmac_f32_16x16x64_bf16 v[200:203], v[16:19], v[192:199], v26
    v_exp_f32 v141, v141
    v_exp_f32 v142, v142
    v_exp_f32 v143, v143
    v_cvt_pk_bf16_f32 v196, v136, v137
    v_cvt_pk_bf16_f32 v197, v138, v139
    v_cvt_pk_bf16_f32 v198, v140, v141
    v_cvt_pk_bf16_f32 v199, v142, v143
    s_waitcnt lgkmcnt(1)
    v_mfma_f32_32x32x16_bf16 v[40:55], v[0:3], v[32:35], v[72:87]
    v_exp_f32 v56, v56
    v_exp_f32 v57, v57
    v_exp_f32 v58, v58
    v_mfma_f32_32x32x16_bf16 v[40:55], v[4:7], v[36:39], v[40:55]
    v_exp_f32 v59, v59
    v_exp_f32 v60, v60
    v_exp_f32 v61, v61
    v_mfma_f32_32x32x16_bf16 v[88:103], v[12:15], v[108:111], v[88:103]
    v_exp_f32 v62, v62
    v_exp_f32 v63, v63
    v_cvt_pk_bf16_f32 v104, v56, v57
    v_cvt_pk_bf16_f32 v105, v58, v59
    v_cvt_pk_bf16_f32 v106, v60, v61
    v_cvt_pk_bf16_f32 v107, v62, v63
    v_exp_f32 v64, v64
    v_exp_f32 v65, v65
    s_waitcnt lgkmcnt(0)
    v_mfma_f32_32x32x16_bf16 v[88:103], v[8:11], v[104:107], v[88:103]
    ds_read_b128 v[28:31], v24
    ds_read_b128 v[208:211], v24 offset:16
    v_exp_f32 v66, v66
    v_exp_f32 v67, v67
    v_exp_f32 v68, v68
    v_smfmac_f32_16x16x64_bf16 v[112:115], v[16:19], v[104:111], v26
    v_exp_f32 v69, v69
    v_exp_f32 v70, v70
    v_exp_f32 v71, v71
    v_cvt_pk_bf16_f32 v108, v64, v65
    v_cvt_pk_bf16_f32 v109, v66, v67
    v_cvt_pk_bf16_f32 v110, v68, v69
    v_cvt_pk_bf16_f32 v111, v70, v71
    v_mfma_f32_32x32x16_bf16 v[128:143], v[0:3], v[120:123], v[160:175]
    ds_read_b128 v[0:3], v21 offset:20480
    v_exp_f32 v144, v144
    v_exp_f32 v145, v145
    v_exp_f32 v146, v146
    v_mfma_f32_32x32x16_bf16 v[128:143], v[4:7], v[124:127], v[128:143]
    ds_read_b128 v[4:7], v21 offset:21504
    v_exp_f32 v147, v147
    v_exp_f32 v148, v148
    v_exp_f32 v149, v149
    v_mfma_f32_32x32x16_bf16 v[176:191], v[12:15], v[196:199], v[176:191]
    ds_read_b128 v[12:15], v22 offset:15360
    v_exp_f32 v150, v150
    v_exp_f32 v151, v151
    v_cvt_pk_bf16_f32 v192, v144, v145
    v_cvt_pk_bf16_f32 v193, v146, v147
    v_cvt_pk_bf16_f32 v194, v148, v149
    v_cvt_pk_bf16_f32 v195, v150, v151
    v_exp_f32 v152, v152
    v_exp_f32 v153, v153
    v_mfma_f32_32x32x16_bf16 v[176:191], v[8:11], v[192:195], v[176:191]
    ds_read_b128 v[8:11], v22 offset:18432
    v_exp_f32 v154, v154
    v_exp_f32 v155, v155
    v_exp_f32 v156, v156
    v_smfmac_f32_16x16x64_bf16 v[200:203], v[16:19], v[192:199], v26
    v_exp_f32 v157, v157
    v_exp_f32 v158, v158
    v_exp_f32 v159, v159
    v_cvt_pk_bf16_f32 v196, v152, v153
    v_cvt_pk_bf16_f32 v197, v154, v155
    v_cvt_pk_bf16_f32 v198, v156, v157
    v_cvt_pk_bf16_f32 v199, v158, v159
    s_waitcnt lgkmcnt(1)
L_p2_chk:
    v_min3_u32 v28, v28, v29, v30
    v_min3_u32 v208, v208, v209, v210
    v_min_u32 v208, v208, v211
    v_add_u32 v208, 1, v208
    v_min3_u32 v28, v28, v31, v208
    v_cmp_gt_u32 vcc, v23, v28
    s_cmp_eq_u64 vcc, 0
    s_cbranch_scc0 L_p2_wait
L_p2_go:
    s_sub_u32 s29, s28, 1
    s_cmp_lt_u32 s29, 5
    s_cselect_b64 vcc, -1, 0
    s_waitcnt lgkmcnt(1)
    v_mfma_f32_32x32x16_bf16 v[56:71], v[0:3], v[32:35], v[72:87]
    v_exp_f32 v40, v40
    v_exp_f32 v41, v41
    v_exp_f32 v42, v42
    v_mfma_f32_32x32x16_bf16 v[56:71], v[4:7], v[36:39], v[56:71]
    s_add_u32 m0, s27, 0
    s_add_u32 s30, s26, 0
    s_cbranch_vccz L_p2_skip0
    buffer_load_dwordx4 v229, s[12:15], s30 offen sc1 lds
L_p2_skip0:
    v_exp_f32 v43, v43
    v_exp_f32 v44, v44
    v_exp_f32 v45, v45
    v_mfma_f32_32x32x16_bf16 v[88:103], v[12:15], v[108:111], v[88:103]
    v_exp_f32 v46, v46
    v_exp_f32 v47, v47
    v_cvt_pk_bf16_f32 v104, v40, v41
    v_cvt_pk_bf16_f32 v105, v42, v43
    v_cvt_pk_bf16_f32 v106, v44, v45
    v_cvt_pk_bf16_f32 v107, v46, v47
    v_exp_f32 v48, v48
    v_exp_f32 v49, v49
    s_waitcnt lgkmcnt(0)
    v_mfma_f32_32x32x16_bf16 v[88:103], v[8:11], v[104:107], v[88:103]
    v_exp_f32 v50, v50
    v_exp_f32 v51, v51
    v_exp_f32 v52, v52
    v_smfmac_f32_16x16x64_bf16 v[112:115], v[16:19], v[104:111], v26
    v_exp_f32 v53, v53
    v_exp_f32 v54, v54
    v_exp_f32 v55, v55
    v_cvt_pk_bf16_f32 v108, v48, v49
    v_cvt_pk_bf16_f32 v109, v50, v51
    v_cvt_pk_bf16_f32 v110, v52, v53
    v_cvt_pk_bf16_f32 v111, v54, v55
    v_mfma_f32_32x32x16_bf16 v[144:159], v[0:3], v[120:123], v[160:175]
    ds_read_b128 v[0:3], v21 offset:24576
    v_exp_f32 v128, v128
    v_exp_f32 v129, v129
    v_exp_f32 v130, v130
    v_mfma_f32_32x32x16_bf16 v[144:159], v[4:7], v[124:127], v[144:159]
    ds_read_b128 v[4:7], v21 offset:25600
    s_cbranch_vccz L_p2_skip1
    buffer_load_dwordx4 v229, s[12:15], s30 offen offset:1024 sc1 lds
L_p2_skip1:
    v_exp_f32 v131, v131
    v_exp_f32 v132, v132
    v_exp_f32 v133, v133
    v_mfma_f32_32x32x16_bf16 v[176:191], v[12:15], v[196:199], v[176:191]
    ds_read_b128 v[12:15], v22 offset:19456
    v_exp_f32 v134, v134
    v_exp_f32 v135, v135
    v_cvt_pk_bf16_f32 v192, v128, v129
    v_cvt_pk_bf16_f32 v193, v130, v131
    v_cvt_pk_bf16_f32 v194, v132, v133
    v_cvt_pk_bf16_f32 v195, v134, v135
    v_exp_f32 v136, v136
    v_exp_f32 v137, v137
    v_mfma_f32_32x32x16_bf16 v[176:191], v[8:11], v[192:195], v[176:191]
    ds_read_b128 v[8:11], v22 offset:22528
    v_exp_f32 v138, v138
    v_exp_f32 v139, v139
    v_exp_f32 v140, v140
    v_smfmac_f32_16x16x64_bf16 v[200:203], v[16:19], v[192:199], v26
    v_exp_f32 v141, v141
    v_exp_f32 v142, v142
    v_exp_f32 v143, v143
    v_cvt_pk_bf16_f32 v196, v136, v137
    v_cvt_pk_bf16_f32 v197, v138, v139
    v_cvt_pk_bf16_f32 v198, v140, v141
    v_cvt_pk_bf16_f32 v199, v142, v143
    s_waitcnt lgkmcnt(1)
    v_mfma_f32_32x32x16_bf16 v[40:55], v[0:3], v[32:35], v[72:87]
    v_exp_f32 v56, v56
    v_exp_f32 v57, v57
    v_exp_f32 v58, v58
    v_mfma_f32_32x32x16_bf16 v[40:55], v[4:7], v[36:39], v[40:55]
    s_cbranch_vccz L_p2_skip2
    buffer_load_dwordx4 v229, s[12:15], s30 offen offset:2048 sc1 lds
L_p2_skip2:
    v_exp_f32 v59, v59
    v_exp_f32 v60, v60
    v_exp_f32 v61, v61
    v_mfma_f32_32x32x16_bf16 v[88:103], v[12:15], v[108:111], v[88:103]
    v_exp_f32 v62, v62
    v_exp_f32 v63, v63
    v_cvt_pk_bf16_f32 v104, v56, v57
    v_cvt_pk_bf16_f32 v105, v58, v59
    v_cvt_pk_bf16_f32 v106, v60, v61
    v_cvt_pk_bf16_f32 v107, v62, v63
    v_exp_f32 v64, v64
    v_exp_f32 v65, v65
    s_waitcnt lgkmcnt(0)
    v_mfma_f32_32x32x16_bf16 v[88:103], v[8:11], v[104:107], v[88:103]
    v_exp_f32 v66, v66
    v_exp_f32 v67, v67
    v_exp_f32 v68, v68
    v_smfmac_f32_16x16x64_bf16 v[112:115], v[16:19], v[104:111], v26
    v_exp_f32 v69, v69
    v_exp_f32 v70, v70
    v_exp_f32 v71, v71
    v_cvt_pk_bf16_f32 v108, v64, v65
    v_cvt_pk_bf16_f32 v109, v66, v67
    v_cvt_pk_bf16_f32 v110, v68, v69
    v_cvt_pk_bf16_f32 v111, v70, v71
    v_mfma_f32_32x32x16_bf16 v[128:143], v[0:3], v[120:123], v[160:175]
    ds_read_b128 v[0:3], v21 offset:28672
    v_exp_f32 v144, v144
    v_exp_f32 v145, v145
    v_exp_f32 v146, v146
    v_mfma_f32_32x32x16_bf16 v[128:143], v[4:7], v[124:127], v[128:143]
    ds_read_b128 v[4:7], v21 offset:29696
    s_cbranch_vccz L_p2_skip3
    buffer_load_dwordx4 v229, s[12:15], s30 offen offset:3072 sc1 lds
L_p2_skip3:
    v_exp_f32 v147, v147
    v_exp_f32 v148, v148
    v_exp_f32 v149, v149
    v_mfma_f32_32x32x16_bf16 v[176:191], v[12:15], v[196:199], v[176:191]
    ds_read_b128 v[12:15], v22 offset:23552
    v_exp_f32 v150, v150
    v_exp_f32 v151, v151
    v_cvt_pk_bf16_f32 v192, v144, v145
    v_cvt_pk_bf16_f32 v193, v146, v147
    v_cvt_pk_bf16_f32 v194, v148, v149
    v_cvt_pk_bf16_f32 v195, v150, v151
    v_exp_f32 v152, v152
    v_exp_f32 v153, v153
    v_mfma_f32_32x32x16_bf16 v[176:191], v[8:11], v[192:195], v[176:191]
    ds_read_b128 v[8:11], v22 offset:26624
    v_exp_f32 v154, v154
    v_exp_f32 v155, v155
    v_exp_f32 v156, v156
    v_smfmac_f32_16x16x64_bf16 v[200:203], v[16:19], v[192:199], v26
    v_exp_f32 v157, v157
    v_exp_f32 v158, v158
    v_exp_f32 v159, v159
    v_cvt_pk_bf16_f32 v196, v152, v153
    v_cvt_pk_bf16_f32 v197, v154, v155
    v_cvt_pk_bf16_f32 v198, v156, v157
    v_cvt_pk_bf16_f32 v199, v158, v159
    s_add_u32 s47, s47, 32768
    s_cmp_ge_u32 s47, 147456
    s_cselect_b32 s47, 49152, s47
    v_add_u32 v21, s47, v229
    s_waitcnt lgkmcnt(1)
    v_mfma_f32_32x32x16_bf16 v[56:71], v[0:3], v[32:35], v[72:87]
    v_exp_f32 v40, v40
    v_exp_f32 v41, v41
    v_exp_f32 v42, v42
    v_mfma_f32_32x32x16_bf16 v[56:71], v[4:7], v[36:39], v[56:71]
    s_add_u32 m0, s27, 4096
    s_add_u32 s30, s26, 4096
    s_cbranch_vccz L_p2_skip4
    buffer_load_dwordx4 v229, s[12:15], s30 offen sc1 lds
L_p2_skip4:
    v_exp_f32 v43, v43
    v_exp_f32 v44, v44
    v_exp_f32 v45, v45
    v_mfma_f32_32x32x16_bf16 v[88:103], v[12:15], v[108:111], v[88:103]
    v_exp_f32 v46, v46
    v_exp_f32 v47, v47
    v_cvt_pk_bf16_f32 v104, v40, v41
    v_cvt_pk_bf16_f32 v105, v42, v43
    v_cvt_pk_bf16_f32 v106, v44, v45
    v_cvt_pk_bf16_f32 v107, v46, v47
    v_exp_f32 v48, v48
    v_exp_f32 v49, v49
    s_waitcnt lgkmcnt(0)
    v_mfma_f32_32x32x16_bf16 v[88:103], v[8:11], v[104:107], v[88:103]
    v_exp_f32 v50, v50
    v_exp_f32 v51, v51
    v_exp_f32 v52, v52
    v_smfmac_f32_16x16x64_bf16 v[112:115], v[16:19], v[104:111], v26
    v_exp_f32 v53, v53
    v_exp_f32 v54, v54
    v_exp_f32 v55, v55
    v_cvt_pk_bf16_f32 v108, v48, v49
    v_cvt_pk_bf16_f32 v109, v50, v51
    v_cvt_pk_bf16_f32 v110, v52, v53
    v_cvt_pk_bf16_f32 v111, v54, v55
    v_mfma_f32_32x32x16_bf16 v[144:159], v[0:3], v[120:123], v[160:175]
    ds_read_b128 v[0:3], v21 offset:0
    v_exp_f32 v128, v128
    v_exp_f32 v129, v129
    v_exp_f32 v130, v130
    v_mfma_f32_32x32x16_bf16 v[144:159], v[4:7], v[124:127], v[144:159]
    ds_read_b128 v[4:7], v21 offset:1024
    s_cbranch_vccz L_p2_skip5
    buffer_load_dwordx4 v229, s[12:15], s30 offen offset:1024 sc1 lds
L_p2_skip5:
    v_exp_f32 v131, v131
    v_exp_f32 v132, v132
    v_exp_f32 v133, v133
    v_mfma_f32_32x32x16_bf16 v[176:191], v[12:15], v[196:199], v[176:191]
    ds_read_b128 v[12:15], v22 offset:27648
    v_exp_f32 v134, v134
    v_exp_f32 v135, v135
    v_cvt_pk_bf16_f32 v192, v128, v129
    v_cvt_pk_bf16_f32 v193, v130, v131
    v_cvt_pk_bf16_f32 v194, v132, v133
    v_cvt_pk_bf16_f32 v195, v134, v135
    v_exp_f32 v136, v136
    v_exp_f32 v137, v137
    v_mfma_f32_32x32x16_bf16 v[176:191], v[8:11], v[192:195], v[176:191]
    ds_read_b128 v[8:11], v22 offset:30720
    v_exp_f32 v138, v138
    v_exp_f32 v139, v139
    v_exp_f32 v140, v140
    v_smfmac_f32_16x16x64_bf16 v[200:203], v[16:19], v[192:199], v26
    v_exp_f32 v141, v141
    v_exp_f32 v142, v142
    v_exp_f32 v143, v143
    v_cvt_pk_bf16_f32 v196, v136, v137
    v_cvt_pk_bf16_f32 v197, v138, v139
    v_cvt_pk_bf16_f32 v198, v140, v141
    v_cvt_pk_bf16_f32 v199, v142, v143
    s_waitcnt lgkmcnt(1)
    v_mfma_f32_32x32x16_bf16 v[40:55], v[0:3], v[32:35], v[72:87]
    v_exp_f32 v56, v56
    v_exp_f32 v57, v57
    v_exp_f32 v58, v58
    v_mfma_f32_32x32x16_bf16 v[40:55], v[4:7], v[36:39], v[40:55]
    s_cbranch_vccz L_p2_skip6
    buffer_load_dwordx4 v229, s[12:15], s30 offen offset:2048 sc1 lds
L_p2_skip6:
    v_exp_f32 v59, v59
    v_exp_f32 v60, v60
    v_exp_f32 v61, v61
    v_mfma_f32_32x32x16_bf16 v[88:103], v[12:15], v[108:111], v[88:103]
    v_exp_f32 v62, v62
    v_exp_f32 v63, v63
    v_cvt_pk_bf16_f32 v104, v56, v57
    v_cvt_pk_bf16_f32 v105, v58, v59
    v_cvt_pk_bf16_f32 v106, v60, v61
    v_cvt_pk_bf16_f32 v107, v62, v63
    v_exp_f32 v64, v64
    v_exp_f32 v65, v65
    s_waitcnt lgkmcnt(0)
    v_mfma_f32_32x32x16_bf16 v[88:103], v[8:11], v[104:107], v[88:103]
    v_exp_f32 v66, v66
    v_exp_f32 v67, v67
    v_exp_f32 v68, v68
    v_smfmac_f32_16x16x64_bf16 v[112:115], v[16:19], v[104:111], v26
    v_exp_f32 v69, v69
    v_exp_f32 v70, v70
    v_exp_f32 v71, v71
    v_cvt_pk_bf16_f32 v108, v64, v65
    v_cvt_pk_bf16_f32 v109, v66, v67
    v_cvt_pk_bf16_f32 v110, v68, v69
    v_cvt_pk_bf16_f32 v111, v70, v71
    v_mfma_f32_32x32x16_bf16 v[128:143], v[0:3], v[120:123], v[160:175]
    ds_read_b128 v[0:3], v21 offset:4096
    v_exp_f32 v144, v144
    v_exp_f32 v145, v145
    v_exp_f32 v146, v146
    v_mfma_f32_32x32x16_bf16 v[128:143], v[4:7], v[124:127], v[128:143]
    ds_read_b128 v[4:7], v21 offset:5120
    s_cbranch_vccz L_p2_skip7
    buffer_load_dwordx4 v229, s[12:15], s30 offen offset:3072 sc1 lds
L_p2_skip7:
    s_add_u32 s26, s26, 32768
    s_add_u32 s27, s27, 32768
    s_sub_u32 s30, s27, 98304
    s_cmp_ge_u32 s27, 147456
    s_cselect_b32 s27, s30, s27
    v_exp_f32 v147, v147
    v_exp_f32 v148, v148
    v_exp_f32 v149, v149
    v_mfma_f32_32x32x16_bf16 v[176:191], v[12:15], v[196:199], v[176:191]
    ds_read_b128 v[12:15], v22 offset:31744
    v_exp_f32 v150, v150
    v_exp_f32 v151, v151
    v_cvt_pk_bf16_f32 v192, v144, v145
    v_cvt_pk_bf16_f32 v193, v146, v147
    v_cvt_pk_bf16_f32 v194, v148, v149
    v_cvt_pk_bf16_f32 v195, v150, v151
    v_exp_f32 v152, v152
    v_exp_f32 v153, v153
    v_add_u32 v22, s47, v229
    v_mfma_f32_32x32x16_bf16 v[176:191], v[8:11], v[192:195], v[176:191]
    ds_read_b128 v[8:11], v22 offset:2048
    v_exp_f32 v154, v154
    v_exp_f32 v155, v155
    v_exp_f32 v156, v156
    v_smfmac_f32_16x16x64_bf16 v[200:203], v[16:19], v[192:199], v26
    v_exp_f32 v157, v157
    v_exp_f32 v158, v158
    v_exp_f32 v159, v159
    v_cvt_pk_bf16_f32 v196, v152, v153
    v_cvt_pk_bf16_f32 v197, v154, v155
    v_cvt_pk_bf16_f32 v198, v156, v157
    v_cvt_pk_bf16_f32 v199, v158, v159
    s_add_u32 s28, s28, 1
    s_cmp_lt_u32 s28, 8
    s_cbranch_scc1 L_p2_loop
    v_mov_b64 v[104:105], 0
    v_mov_b64 v[106:107], 0
    v_mov_b64 v[192:193], 0
    v_mov_b64 v[194:195], 0
    s_waitcnt lgkmcnt(0)
    s_nop 0
    v_mfma_f32_32x32x16_bf16 v[88:103], v[12:15], v[108:111], v[88:103]
    v_smfmac_f32_16x16x64_bf16 v[112:115], v[16:19], v[104:111], v26
    v_mfma_f32_32x32x16_bf16 v[176:191], v[12:15], v[196:199], v[176:191]
    v_smfmac_f32_16x16x64_bf16 v[200:203], v[16:19], v[192:199], v26
    s_nop 15
    s_lshr_b32 s31, s32, 2
    s_mul_i32 s31, s31, 144
    s_add_u32 s31, s31, s24
    s_lshl_b32 s31, s31, 13
    s_and_b32 s30, s32, 2
    s_lshl_b32 s30, s30, 11
    s_add_u32 s31, s31, s30
    s_add_u32 s31, s31, 13500416
    v_add_f32 v112, v112, v113
    v_rcp_f32 v208, v112
    s_nop 0
    v_mul_f32 v88, v88, v208
    v_mul_f32 v89, v89, v208
    v_mul_f32 v90, v90, v208
    v_mul_f32 v91, v91, v208
    v_mul_f32 v92, v92, v208
    v_mul_f32 v93, v93, v208
    v_mul_f32 v94, v94, v208
    v_mul_f32 v95, v95, v208
    v_mul_f32 v96, v96, v208
    v_mul_f32 v97, v97, v208
    v_mul_f32 v98, v98, v208
    v_mul_f32 v99, v99, v208
    v_mul_f32 v100, v100, v208
    v_mul_f32 v101, v101, v208
    v_mul_f32 v102, v102, v208
    v_mul_f32 v103, v103, v208
    v_cvt_pk_bf16_f32 v104, v88, v89
    v_cvt_pk_bf16_f32 v105, v90, v91
    v_cvt_pk_bf16_f32 v106, v92, v93
    v_cvt_pk_bf16_f32 v107, v94, v95
    v_cvt_pk_bf16_f32 v108, v96, v97
    v_cvt_pk_bf16_f32 v109, v98, v99
    v_cvt_pk_bf16_f32 v110, v100, v101
    v_cvt_pk_bf16_f32 v111, v102, v103
    buffer_store_dwordx4 v[104:107], v20, s[4:7], s31 offen offset:0 sc1
    buffer_store_dwordx4 v[108:111], v20, s[4:7], s31 offen offset:512 sc1
    v_add_f32 v200, v200, v201
    v_rcp_f32 v208, v200
    s_nop 0
    v_mul_f32 v176, v176, v208
    v_mul_f32 v177, v177, v208
    v_mul_f32 v178, v178, v208
    v_mul_f32 v179, v179, v208
    v_mul_f32 v180, v180, v208
    v_mul_f32 v181, v181, v208
    v_mul_f32 v182, v182, v208
    v_mul_f32 v183, v183, v208
    v_mul_f32 v184, v184, v208
    v_mul_f32 v185, v185, v208
    v_mul_f32 v186, v186, v208
    v_mul_f32 v187, v187, v208
    v_mul_f32 v188, v188, v208
    v_mul_f32 v189, v189, v208
    v_mul_f32 v190, v190, v208
    v_mul_f32 v191, v191, v208
    v_cvt_pk_bf16_f32 v192, v176, v177
    v_cvt_pk_bf16_f32 v193, v178, v179
    v_cvt_pk_bf16_f32 v194, v180, v181
    v_cvt_pk_bf16_f32 v195, v182, v183
    v_cvt_pk_bf16_f32 v196, v184, v185
    v_cvt_pk_bf16_f32 v197, v186, v187
    v_cvt_pk_bf16_f32 v198, v188, v189
    v_cvt_pk_bf16_f32 v199, v190, v191
    buffer_store_dwordx4 v[192:195], v20, s[4:7], s31 offen offset:2048 sc1
    buffer_store_dwordx4 v[196:199], v20, s[4:7], s31 offen offset:2560 sc1
    v_mov_b32 v210, 0x7c000000
    v_add_f32 v209, abs(v88), abs(v89)
    v_add_f32 v209, v209, abs(v90)
    v_add_f32 v209, v209, abs(v91)
    v_add_f32 v209, v209, abs(v92)
    v_add_f32 v209, v209, abs(v93)
    v_add_f32 v209, v209, abs(v94)
    v_add_f32 v209, v209, abs(v95)
    v_add_f32 v209, v209, abs(v96)
    v_add_f32 v209, v209, abs(v97)
    v_add_f32 v209, v209, abs(v98)
    v_add_f32 v209, v209, abs(v99)
    v_add_f32 v209, v209, abs(v100)
    v_add_f32 v209, v209, abs(v101)
    v_add_f32 v209, v209, abs(v102)
    v_add_f32 v209, v209, abs(v103)
    v_cmp_lt_f32 vcc, v209, v210
    v_cmp_gt_f32 s[36:37], s34, v112
    s_and_b64 vcc, vcc, s[36:37]
    s_cmp_eq_u64 vcc, exec
    s_cbranch_scc0 L_p2_slow0
L_p2_fin0:
    v_add_f32 v209, abs(v176), abs(v177)
    v_add_f32 v209, v209, abs(v178)
    v_add_f32 v209, v209, abs(v179)
    v_add_f32 v209, v209, abs(v180)
    v_add_f32 v209, v209, abs(v181)
    v_add_f32 v209, v209, abs(v182)
    v_add_f32 v209, v209, abs(v183)
    v_add_f32 v209, v209, abs(v184)
    v_add_f32 v209, v209, abs(v185)
    v_add_f32 v209, v209, abs(v186)
    v_add_f32 v209, v209, abs(v187)
    v_add_f32 v209, v209, abs(v188)
    v_add_f32 v209, v209, abs(v189)
    v_add_f32 v209, v209, abs(v190)
    v_add_f32 v209, v209, abs(v191)
    v_cmp_lt_f32 vcc, v209, v210
    v_cmp_gt_f32 s[36:37], s34, v200
    s_and_b64 vcc, vcc, s[36:37]
    s_cmp_eq_u64 vcc, exec
    s_cbranch_scc0 L_p2_slow1
L_p2_fin1:
    s_setprio 0
    s_waitcnt vmcnt(0)
    v_mov_b32 v248, 147492
    v_mov_b32 v249, 1
    s_mov_b64 exec, 1
    ds_add_rtn_u32 v249, v248, v249
    s_waitcnt lgkmcnt(0)
    v_readfirstlane_b32 s80, v249
    s_mov_b64 exec, -1
    s_cmp_eq_u32 s80, 3
    s_cbranch_scc0 L_a_sig
    v_mov_b32 v248, 1
    v_mov_b32 v249, 8
    s_mov_b64 exec, 1
    buffer_atomic_add v248, v249, s[8:11], 0 offen sc0 sc1
    s_waitcnt vmcnt(0)
    v_readfirstlane_b32 s80, v248
    s_mov_b64 exec, -1
    s_cmp_eq_u32 s80, 255
    s_cbranch_scc0 L_a_sig
    v_mov_b32 v248, 1
    s_mov_b64 exec, 1
    buffer_store_dword v248, v249, s[8:11], 0 offen offset:128 sc1
    s_mov_b64 exec, -1
L_a_sig:
    v_and_b32 v248, 1, v228
    v_lshlrev_b32 v248, 2, v248
    v_add_u32 v248, 4, v248
    s_branch L_gemm
L_p2_wait:
    s_add_u32 s35, s35, 1
    s_cmp_gt_u32 s35, 2097152
    s_cbranch_scc1 L_p2_go
    s_sleep 1
    ds_read_b128 v[28:31], v24
    ds_read_b128 v[208:211], v24 offset:16
    s_waitcnt lgkmcnt(0)
    s_branch L_p2_chk
L_p2_slow0:
    v_mov_b32 v208, 0xff800000
    s_mov_b32 s29, s33
    s_mov_b32 s28, 0
L_p2_slow_max0:
    buffer_load_dwordx4 v[0:3], v229, s[4:7], s29 offen sc1
    buffer_load_dwordx4 v[4:7], v229, s[4:7], s29 offen offset:1024 sc1
    s_waitcnt vmcnt(0)
    v_mfma_f32_32x32x16_bf16 v[40:55], v[0:3], v[32:35], 0
    v_mfma_f32_32x32x16_bf16 v[40:55], v[4:7], v[36:39], v[40:55]
    s_nop 15
    v_max3_f32 v208, v208, v40, v41
    v_max3_f32 v208, v208, v42, v43
    v_max3_f32 v208, v208, v44, v45
    v_max3_f32 v208, v208, v46, v47
    v_max3_f32 v208, v208, v48, v49
    v_max3_f32 v208, v208, v50, v51
    v_max3_f32 v208, v208, v52, v53
    v_max3_f32 v208, v208, v54, v55
    s_add_u32 s29, s29, 4096
    s_add_u32 s28, s28, 1
    s_cmp_lt_u32 s28, 64
    s_cbranch_scc1 L_p2_slow_max0
    v_mov_b32 v209, v208
    s_nop 1
    v_permlane32_swap_b32 v209, v208
    s_nop 1
    v_max_f32 v208, v208, v209
    v_sub_f32 v72, 0, v208
    v_mov_b32 v88, 0
    v_sub_f32 v73, 0, v208
    v_mov_b32 v89, 0
    v_sub_f32 v74, 0, v208
    v_mov_b32 v90, 0
    v_sub_f32 v75, 0, v208
    v_mov_b32 v91, 0
    v_sub_f32 v76, 0, v208
    v_mov_b32 v92, 0
    v_sub_f32 v77, 0, v208
    v_mov_b32 v93, 0
    v_sub_f32 v78, 0, v208
    v_mov_b32 v94, 0
    v_sub_f32 v79, 0, v208
    v_mov_b32 v95, 0
    v_sub_f32 v80, 0, v208
    v_mov_b32 v96, 0
    v_sub_f32 v81, 0, v208
    v_mov_b32 v97, 0
    v_sub_f32 v82, 0, v208
    v_mov_b32 v98, 0
    v_sub_f32 v83, 0, v208
    v_mov_b32 v99, 0
    v_sub_f32 v84, 0, v208
    v_mov_b32 v100, 0
    v_sub_f32 v85, 0, v208
    v_mov_b32 v101, 0
    v_sub_f32 v86, 0, v208
    v_mov_b32 v102, 0
    v_sub_f32 v87, 0, v208
    v_mov_b32 v103, 0
    v_mov_b32 v112, 0
    v_mov_b32 v113, 0
    v_mov_b32 v114, 0
    v_mov_b32 v115, 0
    s_mov_b32 s29, s33
    s_mov_b32 s28, 0
L_p2_slow_pv0:
    buffer_load_dwordx4 v[0:3], v229, s[4:7], s29 offen sc1
    buffer_load_dwordx4 v[4:7], v229, s[4:7], s29 offen offset:1024 sc1
    buffer_load_dwordx4 v[8:11], v229, s[4:7], s29 offen offset:2048 sc1
    buffer_load_dwordx4 v[12:15], v229, s[4:7], s29 offen offset:3072 sc1
    s_waitcnt vmcnt(0)
    v_mfma_f32_32x32x16_bf16 v[40:55], v[0:3], v[32:35], v[72:87]
    v_mfma_f32_32x32x16_bf16 v[40:55], v[4:7], v[36:39], v[40:55]
    s_nop 15
    v_exp_f32 v40, v40
    v_exp_f32 v41, v41
    v_exp_f32 v42, v42
    v_exp_f32 v43, v43
    v_exp_f32 v44, v44
    v_exp_f32 v45, v45
    v_exp_f32 v46, v46
    v_exp_f32 v47, v47
    v_exp_f32 v48, v48
    v_exp_f32 v49, v49
    v_exp_f32 v50, v50
    v_exp_f32 v51, v51
    v_exp_f32 v52, v52
    v_exp_f32 v53, v53
    v_exp_f32 v54, v54
    v_exp_f32 v55, v55
    s_nop 0
    v_cvt_pk_bf16_f32 v104, v40, v41
    v_cvt_pk_bf16_f32 v105, v42, v43
    v_cvt_pk_bf16_f32 v106, v44, v45
    v_cvt_pk_bf16_f32 v107, v46, v47
    v_cvt_pk_bf16_f32 v108, v48, v49
    v_cvt_pk_bf16_f32 v109, v50, v51
    v_cvt_pk_bf16_f32 v110, v52, v53
    v_cvt_pk_bf16_f32 v111, v54, v55
    s_nop 1
    v_mfma_f32_32x32x16_bf16 v[88:103], v[8:11], v[104:107], v[88:103]
    v_mfma_f32_32x32x16_bf16 v[88:103], v[12:15], v[108:111], v[88:103]
    v_smfmac_f32_16x16x64_bf16 v[112:115], v[16:19], v[104:111], v26
    s_nop 15
    s_add_u32 s29, s29, 4096
    s_add_u32 s28, s28, 1
    s_cmp_lt_u32 s28, 64
    s_cbranch_scc1 L_p2_slow_pv0
    v_add_f32 v112, v112, v113
    v_rcp_f32 v208, v112
    s_nop 0
    v_mul_f32 v88, v88, v208
    v_mul_f32 v89, v89, v208
    v_mul_f32 v90, v90, v208
    v_mul_f32 v91, v91, v208
    v_mul_f32 v92, v92, v208
    v_mul_f32 v93, v93, v208
    v_mul_f32 v94, v94, v208
    v_mul_f32 v95, v95, v208
    v_mul_f32 v96, v96, v208
    v_mul_f32 v97, v97, v208
    v_mul_f32 v98, v98, v208
    v_mul_f32 v99, v99, v208
    v_mul_f32 v100, v100, v208
    v_mul_f32 v101, v101, v208
    v_mul_f32 v102, v102, v208
    v_mul_f32 v103, v103, v208
    v_cvt_pk_bf16_f32 v104, v88, v89
    v_cvt_pk_bf16_f32 v105, v90, v91
    v_cvt_pk_bf16_f32 v106, v92, v93
    v_cvt_pk_bf16_f32 v107, v94, v95
    v_cvt_pk_bf16_f32 v108, v96, v97
    v_cvt_pk_bf16_f32 v109, v98, v99
    v_cvt_pk_bf16_f32 v110, v100, v101
    v_cvt_pk_bf16_f32 v111, v102, v103
    buffer_store_dwordx4 v[104:107], v20, s[4:7], s31 offen offset:0 sc1
    buffer_store_dwordx4 v[108:111], v20, s[4:7], s31 offen offset:512 sc1
    s_branch L_p2_fin0
L_p2_slow1:
    v_mov_b32 v208, 0xff800000
    s_mov_b32 s29, s33
    s_mov_b32 s28, 0
L_p2_slow_max1:
    buffer_load_dwordx4 v[0:3], v229, s[4:7], s29 offen sc1
    buffer_load_dwordx4 v[4:7], v229, s[4:7], s29 offen offset:1024 sc1
    s_waitcnt vmcnt(0)
    v_mfma_f32_32x32x16_bf16 v[128:143], v[0:3], v[120:123], 0
    v_mfma_f32_32x32x16_bf16 v[128:143], v[4:7], v[124:127], v[128:143]
    s_nop 15
    v_max3_f32 v208, v208, v128, v129
    v_max3_f32 v208, v208, v130, v131
    v_max3_f32 v208, v208, v132, v133
    v_max3_f32 v208, v208, v134, v135
    v_max3_f32 v208, v208, v136, v137
    v_max3_f32 v208, v208, v138, v139
    v_max3_f32 v208, v208, v140, v141
    v_max3_f32 v208, v208, v142, v143
    s_add_u32 s29, s29, 4096
    s_add_u32 s28, s28, 1
    s_cmp_lt_u32 s28, 64
    s_cbranch_scc1 L_p2_slow_max1
    v_mov_b32 v209, v208
    s_nop 1
    v_permlane32_swap_b32 v209, v208
    s_nop 1
    v_max_f32 v208, v208, v209
    v_sub_f32 v160, 0, v208
    v_mov_b32 v176, 0
    v_sub_f32 v161, 0, v208
    v_mov_b32 v177, 0
    v_sub_f32 v162, 0, v208
    v_mov_b32 v178, 0
    v_sub_f32 v163, 0, v208
    v_mov_b32 v179, 0
    v_sub_f32 v164, 0, v208
    v_mov_b32 v180, 0
    v_sub_f32 v165, 0, v208
    v_mov_b32 v181, 0
    v_sub_f32 v166, 0, v208
    v_mov_b32 v182, 0
    v_sub_f32 v167, 0, v208
    v_mov_b32 v183, 0
    v_sub_f32 v168, 0, v208
    v_mov_b32 v184, 0
    v_sub_f32 v169, 0, v208
    v_mov_b32 v185, 0
    v_sub_f32 v170, 0, v208
    v_mov_b32 v186, 0
    v_sub_f32 v171, 0, v208
    v_mov_b32 v187, 0
    v_sub_f32 v172, 0, v208
    v_mov_b32 v188, 0
    v_sub_f32 v173, 0, v208
    v_mov_b32 v189, 0
    v_sub_f32 v174, 0, v208
    v_mov_b32 v190, 0
    v_sub_f32 v175, 0, v208
    v_mov_b32 v191, 0
    v_mov_b32 v200, 0
    v_mov_b32 v201, 0
    v_mov_b32 v202, 0
    v_mov_b32 v203, 0
    s_mov_b32 s29, s33
    s_mov_b32 s28, 0
L_p2_slow_pv1:
    buffer_load_dwordx4 v[0:3], v229, s[4:7], s29 offen sc1
    buffer_load_dwordx4 v[4:7], v229, s[4:7], s29 offen offset:1024 sc1
    buffer_load_dwordx4 v[8:11], v229, s[4:7], s29 offen offset:2048 sc1
    buffer_load_dwordx4 v[12:15], v229, s[4:7], s29 offen offset:3072 sc1
    s_waitcnt vmcnt(0)
    v_mfma_f32_32x32x16_bf16 v[128:143], v[0:3], v[120:123], v[160:175]
    v_mfma_f32_32x32x16_bf16 v[128:143], v[4:7], v[124:127], v[128:143]
    s_nop 15
    v_exp_f32 v128, v128
    v_exp_f32 v129, v129
    v_exp_f32 v130, v130
    v_exp_f32 v131, v131
    v_exp_f32 v132, v132
    v_exp_f32 v133, v133
    v_exp_f32 v134, v134
    v_exp_f32 v135, v135
    v_exp_f32 v136, v136
    v_exp_f32 v137, v137
    v_exp_f32 v138, v138
    v_exp_f32 v139, v139
    v_exp_f32 v140, v140
    v_exp_f32 v141, v141
    v_exp_f32 v142, v142
    v_exp_f32 v143, v143
    s_nop 0
    v_cvt_pk_bf16_f32 v192, v128, v129
    v_cvt_pk_bf16_f32 v193, v130, v131
    v_cvt_pk_bf16_f32 v194, v132, v133
    v_cvt_pk_bf16_f32 v195, v134, v135
    v_cvt_pk_bf16_f32 v196, v136, v137
    v_cvt_pk_bf16_f32 v197, v138, v139
    v_cvt_pk_bf16_f32 v198, v140, v141
    v_cvt_pk_bf16_f32 v199, v142, v143
    s_nop 1
    v_mfma_f32_32x32x16_bf16 v[176:191], v[8:11], v[192:195], v[176:191]
    v_mfma_f32_32x32x16_bf16 v[176:191], v[12:15], v[196:199], v[176:191]
    v_smfmac_f32_16x16x64_bf16 v[200:203], v[16:19], v[192:199], v26
    s_nop 15
    s_add_u32 s29, s29, 4096
    s_add_u32 s28, s28, 1
    s_cmp_lt_u32 s28, 64
    s_cbranch_scc1 L_p2_slow_pv1
    v_add_f32 v200, v200, v201
    v_rcp_f32 v208, v200
    s_nop 0
    v_mul_f32 v176, v176, v208
    v_mul_f32 v177, v177, v208
    v_mul_f32 v178, v178, v208
    v_mul_f32 v179, v179, v208
    v_mul_f32 v180, v180, v208
    v_mul_f32 v181, v181, v208
    v_mul_f32 v182, v182, v208
    v_mul_f32 v183, v183, v208
    v_mul_f32 v184, v184, v208
    v_mul_f32 v185, v185, v208
    v_mul_f32 v186, v186, v208
    v_mul_f32 v187, v187, v208
    v_mul_f32 v188, v188, v208
    v_mul_f32 v189, v189, v208
    v_mul_f32 v190, v190, v208
    v_mul_f32 v191, v191, v208
    v_cvt_pk_bf16_f32 v192, v176, v177
    v_cvt_pk_bf16_f32 v193, v178, v179
    v_cvt_pk_bf16_f32 v194, v180, v181
    v_cvt_pk_bf16_f32 v195, v182, v183
    v_cvt_pk_bf16_f32 v196, v184, v185
    v_cvt_pk_bf16_f32 v197, v186, v187
    v_cvt_pk_bf16_f32 v198, v188, v189
    v_cvt_pk_bf16_f32 v199, v190, v191
    buffer_store_dwordx4 v[192:195], v20, s[4:7], s31 offen offset:2048 sc1
    buffer_store_dwordx4 v[196:199], v20, s[4:7], s31 offen offset:2560 sc1
    s_branch L_p2_fin1
L_g_start:
    s_lshl_b32 s30, s42, 2
    s_add_u32 s30, s30, 147520
    v_mov_b32 v248, s30
    s_mov_b32 s35, 0
L_g_hw:
    ds_read_b32 v249, v248
    s_waitcnt lgkmcnt(0)
    v_cmp_gt_u32 vcc, 1, v249
    s_cmp_eq_u64 vcc, 0
    s_cbranch_scc1 L_g_hw_ok
    s_sleep 2
    s_add_u32 s35, s35, 1
    s_cmp_lt_u32 s35, 2097152
    s_cbranch_scc1 L_g_hw
L_g_hw_ok:
    ds_read_b128 v[0:3], v253 offset:0
    ds_read_b128 v[4:7], v253 offset:1024
    ds_read_b128 v[8:11], v253 offset:2048
    ds_read_b128 v[12:15], v253 offset:3072
    ds_read_b128 v[16:19], v253 offset:4096
    ds_read_b128 v[20:23], v253 offset:5120
    ds_read_b128 v[24:27], v253 offset:6144
    ds_read_b128 v[28:31], v253 offset:7168
    s_add_u32 s26, s26, 65536
    s_add_u32 s27, s27, 65536
    v_mov_b32 v248, 147504
    s_mov_b32 s35, 0
L_g_dw:
    ds_read_b32 v249, v248
    s_waitcnt lgkmcnt(0)
    v_cmp_gt_u32 vcc, 4, v249
    s_cmp_eq_u64 vcc, 0
    s_cbranch_scc1 L_g_dw_ok
    s_sleep 2
    s_add_u32 s35, s35, 1
    s_cmp_lt_u32 s35, 2097152
    s_cbranch_scc1 L_g_dw
L_g_dw_ok:
    s_add_u32 m0, s27, 0
    s_add_u32 s30, s26, 0
    buffer_load_dwordx4 v229, s[12:15], s30 offen sc1 lds
    buffer_load_dwordx4 v229, s[12:15], s30 offen offset:1024 sc1 lds
    buffer_load_dwordx4 v229, s[12:15], s30 offen offset:2048 sc1 lds
    buffer_load_dwordx4 v229, s[12:15], s30 offen offset:3072 sc1 lds
    s_add_u32 m0, s27, 4096
    s_add_u32 s30, s26, 4096
    buffer_load_dwordx4 v229, s[12:15], s30 offen sc1 lds
    buffer_load_dwordx4 v229, s[12:15], s30 offen offset:1024 sc1 lds
    buffer_load_dwordx4 v229, s[12:15], s30 offen offset:2048 sc1 lds
    buffer_load_dwordx4 v229, s[12:15], s30 offen offset:3072 sc1 lds
    s_add_u32 s26, s26, 32768
    s_add_u32 s27, s27, 32768
    s_sub_u32 s30, s27, 98304
    s_cmp_ge_u32 s27, 147456
    s_cselect_b32 s27, s30, s27
    s_lshl_b32 s30, s3, 2
    s_add_u32 s30, s30, 147456
    v_mov_b32 v248, s30
    v_mov_b32 v249, 99
    s_waitcnt vmcnt(0)
    ds_write_b32 v248, v249
    buffer_store_dwordx4 v[192:195], v229, s[4:7], s78 offen offset:0 sc1
    s_waitcnt vmcnt(8)
    buffer_store_dwordx4 v[196:199], v229, s[4:7], s78 offen offset:1024 sc1
    s_waitcnt vmcnt(8)
    buffer_store_dwordx4 v[200:203], v229, s[4:7], s78 offen offset:2048 sc1
    s_waitcnt vmcnt(8)
    buffer_store_dwordx4 v[204:207], v229, s[4:7], s78 offen offset:3072 sc1
    s_waitcnt vmcnt(8)
    buffer_store_dwordx4 v[208:211], v229, s[4:7], s79 offen offset:0 sc1
    s_waitcnt vmcnt(8)
    buffer_store_dwordx4 v[212:215], v229, s[4:7], s79 offen offset:1024 sc1
    s_waitcnt vmcnt(8)
    buffer_store_dwordx4 v[216:219], v229, s[4:7], s79 offen offset:2048 sc1
    s_waitcnt vmcnt(8)
    buffer_store_dwordx4 v[220:223], v229, s[4:7], s79 offen offset:3072 sc1
    s_waitcnt vmcnt(8)
    s_sub_u32 s78, s78, 1179648
    s_sub_u32 s79, s79, 1179648
    buffer_store_dwordx4 v[0:3], v229, s[4:7], s78 offen offset:0 sc1
    s_waitcnt vmcnt(8)
    buffer_store_dwordx4 v[4:7], v229, s[4:7], s78 offen offset:1024 sc1
    s_waitcnt vmcnt(8)
    buffer_store_dwordx4 v[8:11], v229, s[4:7], s78 offen offset:2048 sc1
    s_waitcnt vmcnt(8)
    buffer_store_dwordx4 v[12:15], v229, s[4:7], s78 offen offset:3072 sc1
    s_waitcnt vmcnt(8)
    buffer_store_dwordx4 v[16:19], v229, s[4:7], s79 offen offset:0 sc1
    s_waitcnt vmcnt(8)
    buffer_store_dwordx4 v[20:23], v229, s[4:7], s79 offen offset:1024 sc1
    s_waitcnt vmcnt(8)
    buffer_store_dwordx4 v[24:27], v229, s[4:7], s79 offen offset:2048 sc1
    s_waitcnt vmcnt(8)
    buffer_store_dwordx4 v[28:31], v229, s[4:7], s79 offen offset:3072 sc1
    s_waitcnt vmcnt(8)
    s_waitcnt vmcnt(0)
    v_mov_b32 v248, 147488
    v_mov_b32 v249, 1
    s_mov_b64 exec, 1
    ds_add_rtn_u32 v249, v248, v249
    s_waitcnt lgkmcnt(0)
    v_readfirstlane_b32 s80, v249
    s_mov_b64 exec, -1
    s_cmp_eq_u32 s80, 3
    s_cbranch_scc0 L_g_sig
    v_mov_b32 v248, 1
    v_mov_b32 v249, 4
    s_mov_b64 exec, 1
    buffer_atomic_add v248, v249, s[8:11], 0 offen sc0 sc1
    s_waitcnt vmcnt(0)
    v_readfirstlane_b32 s80, v248
    s_mov_b64 exec, -1
    s_cmp_eq_u32 s80, 255
    s_cbranch_scc0 L_g_sig
    v_mov_b32 v248, 1
    s_mov_b64 exec, 1
    buffer_store_dword v248, v249, s[8:11], 0 offen offset:128 sc1
    s_mov_b64 exec, -1
L_g_sig:
    v_mov_b32 v248, 4
L_gemm:
    s_add_u32 m0, s48, 0
    s_add_u32 s30, s44, 0
    buffer_load_dwordx4 v233, s[20:23], s30 offen lds
    s_add_u32 m0, s48, 1024
    s_add_u32 s30, s44, 16384
    buffer_load_dwordx4 v233, s[20:23], s30 offen lds
    s_add_u32 m0, s48, 2048
    s_add_u32 s30, s44, 32768
    buffer_load_dwordx4 v233, s[20:23], s30 offen lds
    s_add_u32 m0, s48, 3072
    s_add_u32 s30, s44, 49152
    buffer_load_dwordx4 v233, s[20:23], s30 offen lds
    s_add_u32 s44, s44, 262144
    s_add_u32 m0, s48, 4096
    s_add_u32 s30, s44, 0
    buffer_load_dwordx4 v233, s[20:23], s30 offen lds
    s_add_u32 m0, s48, 5120
    s_add_u32 s30, s44, 16384
    buffer_load_dwordx4 v233, s[20:23], s30 offen lds
    s_add_u32 m0, s48, 6144
    s_add_u32 s30, s44, 32768
    buffer_load_dwordx4 v233, s[20:23], s30 offen lds
    s_add_u32 m0, s48, 7168
    s_add_u32 s30, s44, 49152
    buffer_load_dwordx4 v233, s[20:23], s30 offen lds
    s_add_u32 s44, s44, 262144
    v_mov_b64 v[0:1], 0
    v_mov_b64 v[2:3], 0
    v_mov_b64 v[4:5], 0
    v_mov_b64 v[6:7], 0
    v_mov_b64 v[8:9], 0
    v_mov_b64 v[10:11], 0
    v_mov_b64 v[12:13], 0
    v_mov_b64 v[14:15], 0
    v_mov_b64 v[16:17], 0
    v_mov_b64 v[18:19], 0
    v_mov_b64 v[20:21], 0
    v_mov_b64 v[22:23], 0
    v_mov_b64 v[24:25], 0
    v_mov_b64 v[26:27], 0
    v_mov_b64 v[28:29], 0
    v_mov_b64 v[30:31], 0
    v_mov_b64 v[32:33], 0
    v_mov_b64 v[34:35], 0
    v_mov_b64 v[36:37], 0
    v_mov_b64 v[38:39], 0
    v_mov_b64 v[40:41], 0
    v_mov_b64 v[42:43], 0
    v_mov_b64 v[44:45], 0
    v_mov_b64 v[46:47], 0
    v_mov_b64 v[48:49], 0
    v_mov_b64 v[50:51], 0
    v_mov_b64 v[52:53], 0
    v_mov_b64 v[54:55], 0
    v_mov_b64 v[56:57], 0
    v_mov_b64 v[58:59], 0
    v_mov_b64 v[60:61], 0
    v_mov_b64 v[62:63], 0
    v_mov_b64 v[64:65], 0
    v_mov_b64 v[66:67], 0
    v_mov_b64 v[68:69], 0
    v_mov_b64 v[70:71], 0
    v_mov_b64 v[72:73], 0
    v_mov_b64 v[74:75], 0
    v_mov_b64 v[76:77], 0
    v_mov_b64 v[78:79], 0
    v_mov_b64 v[80:81], 0
    v_mov_b64 v[82:83], 0
    v_mov_b64 v[84:85], 0
    v_mov_b64 v[86:87], 0
    v_mov_b64 v[88:89], 0
    v_mov_b64 v[90:91], 0
    v_mov_b64 v[92:93], 0
    v_mov_b64 v[94:95], 0
    v_mov_b64 v[96:97], 0
    v_mov_b64 v[98:99], 0
    v_mov_b64 v[100:101], 0
    v_mov_b64 v[102:103], 0
    v_mov_b64 v[104:105], 0
    v_mov_b64 v[106:107], 0
    v_mov_b64 v[108:109], 0
    v_mov_b64 v[110:111], 0
    v_mov_b64 v[112:113], 0
    v_mov_b64 v[114:115], 0
    v_mov_b64 v[116:117], 0
    v_mov_b64 v[118:119], 0
    v_mov_b64 v[120:121], 0
    v_mov_b64 v[122:123], 0
    v_mov_b64 v[124:125], 0
    v_mov_b64 v[126:127], 0
    s_waitcnt vmcnt(4)
    ds_read_b64_tr_b16 v[160:161], v234 offset:0
    ds_read_b64_tr_b16 v[162:163], v234 offset:2048
    ds_read_b64_tr_b16 v[164:165], v235 offset:0
    ds_read_b64_tr_b16 v[166:167], v235 offset:2048
    ds_read_b64_tr_b16 v[168:169], v236 offset:0
    ds_read_b64_tr_b16 v[170:171], v236 offset:2048
    ds_read_b64_tr_b16 v[172:173], v237 offset:0
    ds_read_b64_tr_b16 v[174:175], v237 offset:2048
    s_waitcnt lgkmcnt(0)
    s_add_u32 m0, s48, 0
    s_add_u32 s30, s44, 0
    buffer_load_dwordx4 v233, s[20:23], s30 offen lds
    s_add_u32 m0, s48, 1024
    s_add_u32 s30, s44, 16384
    buffer_load_dwordx4 v233, s[20:23], s30 offen lds
    s_add_u32 m0, s48, 2048
    s_add_u32 s30, s44, 32768
    buffer_load_dwordx4 v233, s[20:23], s30 offen lds
    s_add_u32 m0, s48, 3072
    s_add_u32 s30, s44, 49152
    buffer_load_dwordx4 v233, s[20:23], s30 offen lds
    s_add_u32 s44, s44, 262144
    buffer_load_dword v250, v248, s[8:11], 0 offen offset:128 sc1
    s_waitcnt vmcnt(0)
    s_mov_b32 s35, 0
L_gemm_c:
    v_cmp_ne_u32 vcc, 1, v250
    s_cmp_eq_u64 vcc, 0
    s_cbranch_scc1 L_gemm_c_ok
    s_sleep 1
    s_sleep 8
    buffer_load_dword v250, v248, s[8:11], 0 offen offset:128 sc1
    s_waitcnt vmcnt(0)
    s_add_u32 s35, s35, 1
    s_cmp_lt_u32 s35, 262144
    s_cbranch_scc1 L_gemm_c
L_gemm_c_ok:
    s_mov_b32 s12, s4
    s_mov_b32 s13, s5
    s_mov_b32 s14, 31506432
    s_mov_b32 s15, 0x00020000
    v_and_b32 v248, 15, v228
    v_lshlrev_b32 v248, 3, v248
    buffer_load_dword v244, v248, s[4:7], s46 offen offset:512 sc1
    buffer_load_dword v245, v248, s[4:7], s46 offen offset:640 sc1
    buffer_load_dword v246, v248, s[4:7], s46 offen offset:768 sc1
    buffer_load_dword v247, v248, s[4:7], s46 offen offset:896 sc1
    buffer_load_dwordx4 v[128:131], v229, s[12:15], s43 offen offset:0 sc1
    buffer_load_dwordx4 v[132:135], v229, s[12:15], s43 offen offset:1024 sc1
    buffer_load_dwordx4 v[136:139], v229, s[12:15], s43 offen offset:2048 sc1
    buffer_load_dwordx4 v[140:143], v229, s[12:15], s43 offen offset:3072 sc1
    buffer_load_dwordx4 v[144:147], v232, s[12:15], s43 offen offset:0 sc1
    buffer_load_dwordx4 v[148:151], v232, s[12:15], s43 offen offset:1024 sc1
    buffer_load_dwordx4 v[152:155], v232, s[12:15], s43 offen offset:2048 sc1
    buffer_load_dwordx4 v[156:159], v232, s[12:15], s43 offen offset:3072 sc1
    s_add_u32 s43, s43, 32768
    buffer_load_dword v240, v248, s[4:7], s46 offen offset:0 sc1
    buffer_load_dword v241, v248, s[4:7], s46 offen offset:128 sc1
    buffer_load_dword v242, v248, s[4:7], s46 offen offset:256 sc1
    buffer_load_dword v243, v248, s[4:7], s46 offen offset:384 sc1
    buffer_load_dwordx4 v[176:179], v229, s[12:15], s43 offen offset:0 sc1
    buffer_load_dwordx4 v[180:183], v229, s[12:15], s43 offen offset:1024 sc1
    buffer_load_dwordx4 v[184:187], v229, s[12:15], s43 offen offset:2048 sc1
    buffer_load_dwordx4 v[188:191], v229, s[12:15], s43 offen offset:3072 sc1
    buffer_load_dwordx4 v[192:195], v232, s[12:15], s43 offen offset:0 sc1
    buffer_load_dwordx4 v[196:199], v232, s[12:15], s43 offen offset:1024 sc1
    buffer_load_dwordx4 v[200:203], v232, s[12:15], s43 offen offset:2048 sc1
    buffer_load_dwordx4 v[204:207], v232, s[12:15], s43 offen offset:3072 sc1
    s_add_u32 s43, s43, 32768
.p2align 6
L_gemm_loop:
    s_cmp_eq_u32 s45, 1
    s_cselect_b32 s14, 0, s14
    s_waitcnt vmcnt(12) lgkmcnt(0)
    v_mfma_f32_16x16x32_bf16 v[0:3], v[160:163], v[128:131], v[0:3]
    ds_read_b64_tr_b16 v[208:209], v234 offset:4096
    v_mfma_f32_16x16x32_bf16 v[4:7], v[164:167], v[128:131], v[4:7]
    ds_read_b64_tr_b16 v[210:211], v234 offset:6144
    v_mfma_f32_16x16x32_bf16 v[8:11], v[168:171], v[128:131], v[8:11]
    ds_read_b64_tr_b16 v[212:213], v235 offset:4096
    v_mfma_f32_16x16x32_bf16 v[12:15], v[172:175], v[128:131], v[12:15]
    ds_read_b64_tr_b16 v[214:215], v235 offset:6144
    buffer_load_dwordx4 v[128:131], v229, s[12:15], s43 offen offset:0 sc1
    v_mfma_f32_16x16x32_bf16 v[16:19], v[160:163], v[132:135], v[16:19]
    ds_read_b64_tr_b16 v[216:217], v236 offset:4096
    v_mfma_f32_16x16x32_bf16 v[20:23], v[164:167], v[132:135], v[20:23]
    ds_read_b64_tr_b16 v[218:219], v236 offset:6144
    v_mfma_f32_16x16x32_bf16 v[24:27], v[168:171], v[132:135], v[24:27]
    ds_read_b64_tr_b16 v[220:221], v237 offset:4096
    v_mfma_f32_16x16x32_bf16 v[28:31], v[172:175], v[132:135], v[28:31]
    ds_read_b64_tr_b16 v[222:223], v237 offset:6144
    buffer_load_dwordx4 v[132:135], v229, s[12:15], s43 offen offset:1024 sc1
    v_mfma_f32_16x16x32_bf16 v[32:35], v[160:163], v[136:139], v[32:35]
    v_mfma_f32_16x16x32_bf16 v[36:39], v[164:167], v[136:139], v[36:39]
    v_mfma_f32_16x16x32_bf16 v[40:43], v[168:171], v[136:139], v[40:43]
    v_mfma_f32_16x16x32_bf16 v[44:47], v[172:175], v[136:139], v[44:47]
    buffer_load_dwordx4 v[136:139], v229, s[12:15], s43 offen offset:2048 sc1
    s_waitcnt lgkmcnt(0)
    v_mfma_f32_16x16x32_bf16 v[48:51], v[160:163], v[140:143], v[48:51]
    v_mfma_f32_16x16x32_bf16 v[52:55], v[164:167], v[140:143], v[52:55]
    s_add_u32 m0, s48, 4096
    s_add_u32 s30, s44, 0
    buffer_load_dwordx4 v233, s[20:23], s30 offen lds
    v_mfma_f32_16x16x32_bf16 v[56:59], v[168:171], v[140:143], v[56:59]
    v_mfma_f32_16x16x32_bf16 v[60:63], v[172:175], v[140:143], v[60:63]
    buffer_load_dwordx4 v[140:143], v229, s[12:15], s43 offen offset:3072 sc1
    v_mfma_f32_16x16x32_bf16 v[64:67], v[160:163], v[144:147], v[64:67]
    v_mfma_f32_16x16x32_bf16 v[68:71], v[164:167], v[144:147], v[68:71]
    s_add_u32 m0, s48, 5120
    s_add_u32 s30, s44, 16384
    buffer_load_dwordx4 v233, s[20:23], s30 offen lds
    v_mfma_f32_16x16x32_bf16 v[72:75], v[168:171], v[144:147], v[72:75]
    v_mfma_f32_16x16x32_bf16 v[76:79], v[172:175], v[144:147], v[76:79]
    buffer_load_dwordx4 v[144:147], v232, s[12:15], s43 offen offset:0 sc1
    v_mfma_f32_16x16x32_bf16 v[80:83], v[160:163], v[148:151], v[80:83]
    v_mfma_f32_16x16x32_bf16 v[84:87], v[164:167], v[148:151], v[84:87]
    s_add_u32 m0, s48, 6144
    s_add_u32 s30, s44, 32768
    buffer_load_dwordx4 v233, s[20:23], s30 offen lds
    v_mfma_f32_16x16x32_bf16 v[88:91], v[168:171], v[148:151], v[88:91]
    v_mfma_f32_16x16x32_bf16 v[92:95], v[172:175], v[148:151], v[92:95]
    buffer_load_dwordx4 v[148:151], v232, s[12:15], s43 offen offset:1024 sc1
    v_mfma_f32_16x16x32_bf16 v[96:99], v[160:163], v[152:155], v[96:99]
    v_mfma_f32_16x16x32_bf16 v[100:103], v[164:167], v[152:155], v[100:103]
    s_add_u32 m0, s48, 7168
    s_add_u32 s30, s44, 49152
    buffer_load_dwordx4 v233, s[20:23], s30 offen lds
    s_add_u32 s44, s44, 262144
    v_mfma_f32_16x16x32_bf16 v[104:107], v[168:171], v[152:155], v[104:107]
    v_mfma_f32_16x16x32_bf16 v[108:111], v[172:175], v[152:155], v[108:111]
    buffer_load_dwordx4 v[152:155], v232, s[12:15], s43 offen offset:2048 sc1
    v_mfma_f32_16x16x32_bf16 v[112:115], v[160:163], v[156:159], v[112:115]
    v_mfma_f32_16x16x32_bf16 v[116:119], v[164:167], v[156:159], v[116:119]
    v_mfma_f32_16x16x32_bf16 v[120:123], v[168:171], v[156:159], v[120:123]
    v_mfma_f32_16x16x32_bf16 v[124:127], v[172:175], v[156:159], v[124:127]
    buffer_load_dwordx4 v[156:159], v232, s[12:15], s43 offen offset:3072 sc1
    s_add_u32 s43, s43, 32768
    s_waitcnt vmcnt(12) lgkmcnt(0)
    v_mfma_f32_16x16x32_bf16 v[0:3], v[208:211], v[176:179], v[0:3]
    ds_read_b64_tr_b16 v[160:161], v234 offset:0
    v_mfma_f32_16x16x32_bf16 v[4:7], v[212:215], v[176:179], v[4:7]
    ds_read_b64_tr_b16 v[162:163], v234 offset:2048
    v_mfma_f32_16x16x32_bf16 v[8:11], v[216:219], v[176:179], v[8:11]
    ds_read_b64_tr_b16 v[164:165], v235 offset:0
    v_mfma_f32_16x16x32_bf16 v[12:15], v[220:223], v[176:179], v[12:15]
    ds_read_b64_tr_b16 v[166:167], v235 offset:2048
    buffer_load_dwordx4 v[176:179], v229, s[12:15], s43 offen offset:0 sc1
    v_mfma_f32_16x16x32_bf16 v[16:19], v[208:211], v[180:183], v[16:19]
    ds_read_b64_tr_b16 v[168:169], v236 offset:0
    v_mfma_f32_16x16x32_bf16 v[20:23], v[212:215], v[180:183], v[20:23]
    ds_read_b64_tr_b16 v[170:171], v236 offset:2048
    v_mfma_f32_16x16x32_bf16 v[24:27], v[216:219], v[180:183], v[24:27]
    ds_read_b64_tr_b16 v[172:173], v237 offset:0
    v_mfma_f32_16x16x32_bf16 v[28:31], v[220:223], v[180:183], v[28:31]
    ds_read_b64_tr_b16 v[174:175], v237 offset:2048
    buffer_load_dwordx4 v[180:183], v229, s[12:15], s43 offen offset:1024 sc1
    v_mfma_f32_16x16x32_bf16 v[32:35], v[208:211], v[184:187], v[32:35]
    v_mfma_f32_16x16x32_bf16 v[36:39], v[212:215], v[184:187], v[36:39]
    v_mfma_f32_16x16x32_bf16 v[40:43], v[216:219], v[184:187], v[40:43]
    v_mfma_f32_16x16x32_bf16 v[44:47], v[220:223], v[184:187], v[44:47]
    buffer_load_dwordx4 v[184:187], v229, s[12:15], s43 offen offset:2048 sc1
    s_waitcnt lgkmcnt(0)
    v_mfma_f32_16x16x32_bf16 v[48:51], v[208:211], v[188:191], v[48:51]
    v_mfma_f32_16x16x32_bf16 v[52:55], v[212:215], v[188:191], v[52:55]
    s_add_u32 m0, s48, 0
    s_add_u32 s30, s44, 0
    buffer_load_dwordx4 v233, s[20:23], s30 offen lds
    v_mfma_f32_16x16x32_bf16 v[56:59], v[216:219], v[188:191], v[56:59]
    v_mfma_f32_16x16x32_bf16 v[60:63], v[220:223], v[188:191], v[60:63]
    buffer_load_dwordx4 v[188:191], v229, s[12:15], s43 offen offset:3072 sc1
    v_mfma_f32_16x16x32_bf16 v[64:67], v[208:211], v[192:195], v[64:67]
    v_mfma_f32_16x16x32_bf16 v[68:71], v[212:215], v[192:195], v[68:71]
    s_add_u32 m0, s48, 1024
    s_add_u32 s30, s44, 16384
    buffer_load_dwordx4 v233, s[20:23], s30 offen lds
    v_mfma_f32_16x16x32_bf16 v[72:75], v[216:219], v[192:195], v[72:75]
    v_mfma_f32_16x16x32_bf16 v[76:79], v[220:223], v[192:195], v[76:79]
    buffer_load_dwordx4 v[192:195], v232, s[12:15], s43 offen offset:0 sc1
    v_mfma_f32_16x16x32_bf16 v[80:83], v[208:211], v[196:199], v[80:83]
    v_mfma_f32_16x16x32_bf16 v[84:87], v[212:215], v[196:199], v[84:87]
    s_add_u32 m0, s48, 2048
    s_add_u32 s30, s44, 32768
    buffer_load_dwordx4 v233, s[20:23], s30 offen lds
    v_mfma_f32_16x16x32_bf16 v[88:91], v[216:219], v[196:199], v[88:91]
    v_mfma_f32_16x16x32_bf16 v[92:95], v[220:223], v[196:199], v[92:95]
    buffer_load_dwordx4 v[196:199], v232, s[12:15], s43 offen offset:1024 sc1
    v_mfma_f32_16x16x32_bf16 v[96:99], v[208:211], v[200:203], v[96:99]
    v_mfma_f32_16x16x32_bf16 v[100:103], v[212:215], v[200:203], v[100:103]
    s_add_u32 m0, s48, 3072
    s_add_u32 s30, s44, 49152
    buffer_load_dwordx4 v233, s[20:23], s30 offen lds
    s_add_u32 s44, s44, 262144
    v_mfma_f32_16x16x32_bf16 v[104:107], v[216:219], v[200:203], v[104:107]
    v_mfma_f32_16x16x32_bf16 v[108:111], v[220:223], v[200:203], v[108:111]
    buffer_load_dwordx4 v[200:203], v232, s[12:15], s43 offen offset:2048 sc1
    v_mfma_f32_16x16x32_bf16 v[112:115], v[208:211], v[204:207], v[112:115]
    v_mfma_f32_16x16x32_bf16 v[116:119], v[212:215], v[204:207], v[116:119]
    v_mfma_f32_16x16x32_bf16 v[120:123], v[216:219], v[204:207], v[120:123]
    v_mfma_f32_16x16x32_bf16 v[124:127], v[220:223], v[204:207], v[124:127]
    buffer_load_dwordx4 v[204:207], v232, s[12:15], s43 offen offset:3072 sc1
    s_add_u32 s43, s43, 32768
    s_sub_u32 s45, s45, 1
    s_cmp_lg_u32 s45, 0
    s_cbranch_scc1 L_gemm_loop
    s_waitcnt vmcnt(0) lgkmcnt(0)
    s_lshl_b32 s29, s42, 15
    v_add_u32 v251, s29, v229
    s_lshl_b32 s29, s42, 13
    v_add_u32 v252, s29, v229
    v_add_u32 v253, 65536, v252
    s_cmp_lt_u32 s3, 4
    s_cbranch_scc0 L_g_red
    s_barrier
    ds_write_b128 v251, v[0:3] offset:0
    ds_write_b128 v251, v[4:7] offset:1024
    ds_write_b128 v251, v[8:11] offset:2048
    ds_write_b128 v251, v[12:15] offset:3072
    ds_write_b128 v251, v[16:19] offset:4096
    ds_write_b128 v251, v[20:23] offset:5120
    ds_write_b128 v251, v[24:27] offset:6144
    ds_write_b128 v251, v[28:31] offset:7168
    ds_write_b128 v251, v[32:35] offset:8192
    ds_write_b128 v251, v[36:39] offset:9216
    ds_write_b128 v251, v[40:43] offset:10240
    ds_write_b128 v251, v[44:47] offset:11264
    ds_write_b128 v251, v[48:51] offset:12288
    ds_write_b128 v251, v[52:55] offset:13312
    ds_write_b128 v251, v[56:59] offset:14336
    ds_write_b128 v251, v[60:63] offset:15360
    ds_write_b128 v251, v[64:67] offset:16384
    ds_write_b128 v251, v[68:71] offset:17408
    ds_write_b128 v251, v[72:75] offset:18432
    ds_write_b128 v251, v[76:79] offset:19456
    ds_write_b128 v251, v[80:83] offset:20480
    ds_write_b128 v251, v[84:87] offset:21504
    ds_write_b128 v251, v[88:91] offset:22528
    ds_write_b128 v251, v[92:95] offset:23552
    ds_write_b128 v251, v[96:99] offset:24576
    ds_write_b128 v251, v[100:103] offset:25600
    ds_write_b128 v251, v[104:107] offset:26624
    ds_write_b128 v251, v[108:111] offset:27648
    ds_write_b128 v251, v[112:115] offset:28672
    ds_write_b128 v251, v[116:119] offset:29696
    ds_write_b128 v251, v[120:123] offset:30720
    ds_write_b128 v251, v[124:127] offset:31744
    s_waitcnt lgkmcnt(0)
    s_barrier
    s_endpgm
L_g_red:
    v_mul_f32 v0, v0, v240
    v_mul_f32 v1, v1, v240
    v_mul_f32 v2, v2, v240
    v_mul_f32 v3, v3, v240
    v_mul_f32 v4, v4, v240
    v_mul_f32 v5, v5, v240
    v_mul_f32 v6, v6, v240
    v_mul_f32 v7, v7, v240
    v_mul_f32 v8, v8, v240
    v_mul_f32 v9, v9, v240
    v_mul_f32 v10, v10, v240
    v_mul_f32 v11, v11, v240
    v_mul_f32 v12, v12, v240
    v_mul_f32 v13, v13, v240
    v_mul_f32 v14, v14, v240
    v_mul_f32 v15, v15, v240
    v_mul_f32 v16, v16, v241
    v_mul_f32 v17, v17, v241
    v_mul_f32 v18, v18, v241
    v_mul_f32 v19, v19, v241
    v_mul_f32 v20, v20, v241
    v_mul_f32 v21, v21, v241
    v_mul_f32 v22, v22, v241
    v_mul_f32 v23, v23, v241
    v_mul_f32 v24, v24, v241
    v_mul_f32 v25, v25, v241
    v_mul_f32 v26, v26, v241
    v_mul_f32 v27, v27, v241
    v_mul_f32 v28, v28, v241
    v_mul_f32 v29, v29, v241
    v_mul_f32 v30, v30, v241
    v_mul_f32 v31, v31, v241
    v_mul_f32 v32, v32, v242
    v_mul_f32 v33, v33, v242
    v_mul_f32 v34, v34, v242
    v_mul_f32 v35, v35, v242
    v_mul_f32 v36, v36, v242
    v_mul_f32 v37, v37, v242
    v_mul_f32 v38, v38, v242
    v_mul_f32 v39, v39, v242
    v_mul_f32 v40, v40, v242
    v_mul_f32 v41, v41, v242
    v_mul_f32 v42, v42, v242
    v_mul_f32 v43, v43, v242
    v_mul_f32 v44, v44, v242
    v_mul_f32 v45, v45, v242
    v_mul_f32 v46, v46, v242
    v_mul_f32 v47, v47, v242
    v_mul_f32 v48, v48, v243
    v_mul_f32 v49, v49, v243
    v_mul_f32 v50, v50, v243
    v_mul_f32 v51, v51, v243
    v_mul_f32 v52, v52, v243
    v_mul_f32 v53, v53, v243
    v_mul_f32 v54, v54, v243
    v_mul_f32 v55, v55, v243
    v_mul_f32 v56, v56, v243
    v_mul_f32 v57, v57, v243
    v_mul_f32 v58, v58, v243
    v_mul_f32 v59, v59, v243
    v_mul_f32 v60, v60, v243
    v_mul_f32 v61, v61, v243
    v_mul_f32 v62, v62, v243
    v_mul_f32 v63, v63, v243
    v_mul_f32 v64, v64, v244
    v_mul_f32 v65, v65, v244
    v_mul_f32 v66, v66, v244
    v_mul_f32 v67, v67, v244
    v_mul_f32 v68, v68, v244
    v_mul_f32 v69, v69, v244
    v_mul_f32 v70, v70, v244
    v_mul_f32 v71, v71, v244
    v_mul_f32 v72, v72, v244
    v_mul_f32 v73, v73, v244
    v_mul_f32 v74, v74, v244
    v_mul_f32 v75, v75, v244
    v_mul_f32 v76, v76, v244
    v_mul_f32 v77, v77, v244
    v_mul_f32 v78, v78, v244
    v_mul_f32 v79, v79, v244
    v_mul_f32 v80, v80, v245
    v_mul_f32 v81, v81, v245
    v_mul_f32 v82, v82, v245
    v_mul_f32 v83, v83, v245
    v_mul_f32 v84, v84, v245
    v_mul_f32 v85, v85, v245
    v_mul_f32 v86, v86, v245
    v_mul_f32 v87, v87, v245
    v_mul_f32 v88, v88, v245
    v_mul_f32 v89, v89, v245
    v_mul_f32 v90, v90, v245
    v_mul_f32 v91, v91, v245
    v_mul_f32 v92, v92, v245
    v_mul_f32 v93, v93, v245
    v_mul_f32 v94, v94, v245
    v_mul_f32 v95, v95, v245
    v_mul_f32 v96, v96, v246
    v_mul_f32 v97, v97, v246
    v_mul_f32 v98, v98, v246
    v_mul_f32 v99, v99, v246
    v_mul_f32 v100, v100, v246
    v_mul_f32 v101, v101, v246
    v_mul_f32 v102, v102, v246
    v_mul_f32 v103, v103, v246
    v_mul_f32 v104, v104, v246
    v_mul_f32 v105, v105, v246
    v_mul_f32 v106, v106, v246
    v_mul_f32 v107, v107, v246
    v_mul_f32 v108, v108, v246
    v_mul_f32 v109, v109, v246
    v_mul_f32 v110, v110, v246
    v_mul_f32 v111, v111, v246
    v_mul_f32 v112, v112, v247
    v_mul_f32 v113, v113, v247
    v_mul_f32 v114, v114, v247
    v_mul_f32 v115, v115, v247
    v_mul_f32 v116, v116, v247
    v_mul_f32 v117, v117, v247
    v_mul_f32 v118, v118, v247
    v_mul_f32 v119, v119, v247
    v_mul_f32 v120, v120, v247
    v_mul_f32 v121, v121, v247
    v_mul_f32 v122, v122, v247
    v_mul_f32 v123, v123, v247
    v_mul_f32 v124, v124, v247
    v_mul_f32 v125, v125, v247
    v_mul_f32 v126, v126, v247
    v_mul_f32 v127, v127, v247
    v_and_b32 v248, 15, v228
    v_lshlrev_b32 v248, 3, v248
    s_lshl_b32 s29, s42, 8
    s_add_u32 s29, s29, s46
    s_sub_u32 s29, s29, 4
    buffer_load_dword v240, v248, s[4:7], s29 offen sc1
    buffer_load_dword v241, v248, s[4:7], s29 offen offset:128 sc1
    v_mov_b32 v248, 147492
    s_mov_b32 s35, 0
L_g_wa:
    ds_read_b32 v249, v248
    s_waitcnt lgkmcnt(0)
    v_cmp_gt_u32 vcc, 4, v249
    s_cmp_eq_u64 vcc, 0
    s_cbranch_scc1 L_g_wa_ok
    s_sleep 2
    s_add_u32 s35, s35, 1
    s_cmp_lt_u32 s35, 2097152
    s_cbranch_scc1 L_g_wa
L_g_wa_ok:
    s_cmp_gt_u32 0, s42
    s_cselect_b32 s30, 1, 0
    s_sub_u32 s30, 0, s30
    s_lshl_b32 s31, s42, 1
    s_add_u32 s31, s31, s30
    s_add_u32 s31, s31, 9
    s_cmp_eq_u32 s30, 0
    s_cselect_b32 s31, s42, s31
    s_lshl_b32 s31, s31, 13
    v_add_u32 v248, s31, v229
    s_cmp_eq_u32 s42, 0
    s_cbranch_scc1 L_g_own0
    ds_write_b128 v248, v[0:3] offset:0
    ds_write_b128 v248, v[4:7] offset:1024
    ds_write_b128 v248, v[8:11] offset:2048
    ds_write_b128 v248, v[12:15] offset:3072
    ds_write_b128 v248, v[16:19] offset:4096
    ds_write_b128 v248, v[20:23] offset:5120
    ds_write_b128 v248, v[24:27] offset:6144
    ds_write_b128 v248, v[28:31] offset:7168
    s_branch L_g_nxt0
L_g_own0:
    v_mov_b64 v[128:129], v[0:1]
    v_mov_b64 v[130:131], v[2:3]
    v_mov_b64 v[132:133], v[4:5]
    v_mov_b64 v[134:135], v[6:7]
    v_mov_b64 v[136:137], v[8:9]
    v_mov_b64 v[138:139], v[10:11]
    v_mov_b64 v[140:141], v[12:13]
    v_mov_b64 v[142:143], v[14:15]
    v_mov_b64 v[144:145], v[16:17]
    v_mov_b64 v[146:147], v[18:19]
    v_mov_b64 v[148:149], v[20:21]
    v_mov_b64 v[150:151], v[22:23]
    v_mov_b64 v[152:153], v[24:25]
    v_mov_b64 v[154:155], v[26:27]
    v_mov_b64 v[156:157], v[28:29]
    v_mov_b64 v[158:159], v[30:31]
L_g_nxt0:
    s_cmp_gt_u32 1, s42
    s_cselect_b32 s30, 1, 0
    s_sub_u32 s30, 1, s30
    s_lshl_b32 s31, s42, 1
    s_add_u32 s31, s31, s30
    s_add_u32 s31, s31, 9
    s_cmp_eq_u32 s30, 0
    s_cselect_b32 s31, s42, s31
    s_lshl_b32 s31, s31, 13
    v_add_u32 v248, s31, v229
    s_cmp_eq_u32 s42, 1
    s_cbranch_scc1 L_g_own1
    ds_write_b128 v248, v[32:35] offset:0
    ds_write_b128 v248, v[36:39] offset:1024
    ds_write_b128 v248, v[40:43] offset:2048
    ds_write_b128 v248, v[44:47] offset:3072
    ds_write_b128 v248, v[48:51] offset:4096
    ds_write_b128 v248, v[52:55] offset:5120
    ds_write_b128 v248, v[56:59] offset:6144
    ds_write_b128 v248, v[60:63] offset:7168
    s_branch L_g_nxt1
L_g_own1:
    v_mov_b64 v[128:129], v[32:33]
    v_mov_b64 v[130:131], v[34:35]
    v_mov_b64 v[132:133], v[36:37]
    v_mov_b64 v[134:135], v[38:39]
    v_mov_b64 v[136:137], v[40:41]
    v_mov_b64 v[138:139], v[42:43]
    v_mov_b64 v[140:141], v[44:45]
    v_mov_b64 v[142:143], v[46:47]
    v_mov_b64 v[144:145], v[48:49]
    v_mov_b64 v[146:147], v[50:51]
    v_mov_b64 v[148:149], v[52:53]
    v_mov_b64 v[150:151], v[54:55]
    v_mov_b64 v[152:153], v[56:57]
    v_mov_b64 v[154:155], v[58:59]
    v_mov_b64 v[156:157], v[60:61]
    v_mov_b64 v[158:159], v[62:63]
L_g_nxt1:
    s_cmp_gt_u32 2, s42
    s_cselect_b32 s30, 1, 0
    s_sub_u32 s30, 2, s30
    s_lshl_b32 s31, s42, 1
    s_add_u32 s31, s31, s30
    s_add_u32 s31, s31, 9
    s_cmp_eq_u32 s30, 0
    s_cselect_b32 s31, s42, s31
    s_lshl_b32 s31, s31, 13
    v_add_u32 v248, s31, v229
    s_cmp_eq_u32 s42, 2
    s_cbranch_scc1 L_g_own2
    ds_write_b128 v248, v[64:67] offset:0
    ds_write_b128 v248, v[68:71] offset:1024
    ds_write_b128 v248, v[72:75] offset:2048
    ds_write_b128 v248, v[76:79] offset:3072
    ds_write_b128 v248, v[80:83] offset:4096
    ds_write_b128 v248, v[84:87] offset:5120
    ds_write_b128 v248, v[88:91] offset:6144
    ds_write_b128 v248, v[92:95] offset:7168
    s_branch L_g_nxt2
L_g_own2:
    v_mov_b64 v[128:129], v[64:65]
    v_mov_b64 v[130:131], v[66:67]
    v_mov_b64 v[132:133], v[68:69]
    v_mov_b64 v[134:135], v[70:71]
    v_mov_b64 v[136:137], v[72:73]
    v_mov_b64 v[138:139], v[74:75]
    v_mov_b64 v[140:141], v[76:77]
    v_mov_b64 v[142:143], v[78:79]
    v_mov_b64 v[144:145], v[80:81]
    v_mov_b64 v[146:147], v[82:83]
    v_mov_b64 v[148:149], v[84:85]
    v_mov_b64 v[150:151], v[86:87]
    v_mov_b64 v[152:153], v[88:89]
    v_mov_b64 v[154:155], v[90:91]
    v_mov_b64 v[156:157], v[92:93]
    v_mov_b64 v[158:159], v[94:95]
L_g_nxt2:
    s_cmp_gt_u32 3, s42
    s_cselect_b32 s30, 1, 0
    s_sub_u32 s30, 3, s30
    s_lshl_b32 s31, s42, 1
    s_add_u32 s31, s31, s30
    s_add_u32 s31, s31, 9
    s_cmp_eq_u32 s30, 0
    s_cselect_b32 s31, s42, s31
    s_lshl_b32 s31, s31, 13
    v_add_u32 v248, s31, v229
    s_cmp_eq_u32 s42, 3
    s_cbranch_scc1 L_g_own3
    ds_write_b128 v248, v[96:99] offset:0
    ds_write_b128 v248, v[100:103] offset:1024
    ds_write_b128 v248, v[104:107] offset:2048
    ds_write_b128 v248, v[108:111] offset:3072
    ds_write_b128 v248, v[112:115] offset:4096
    ds_write_b128 v248, v[116:119] offset:5120
    ds_write_b128 v248, v[120:123] offset:6144
    ds_write_b128 v248, v[124:127] offset:7168
    s_branch L_g_nxt3
L_g_own3:
    v_mov_b64 v[128:129], v[96:97]
    v_mov_b64 v[130:131], v[98:99]
    v_mov_b64 v[132:133], v[100:101]
    v_mov_b64 v[134:135], v[102:103]
    v_mov_b64 v[136:137], v[104:105]
    v_mov_b64 v[138:139], v[106:107]
    v_mov_b64 v[140:141], v[108:109]
    v_mov_b64 v[142:143], v[110:111]
    v_mov_b64 v[144:145], v[112:113]
    v_mov_b64 v[146:147], v[114:115]
    v_mov_b64 v[148:149], v[116:117]
    v_mov_b64 v[150:151], v[118:119]
    v_mov_b64 v[152:153], v[120:121]
    v_mov_b64 v[154:155], v[122:123]
    v_mov_b64 v[156:157], v[124:125]
    v_mov_b64 v[158:159], v[126:127]
L_g_nxt3:
    s_waitcnt lgkmcnt(0)
    v_mov_b32 v248, 147496
    v_mov_b32 v249, 1
    s_mov_b64 exec, 1
    ds_add_rtn_u32 v249, v248, v249
    s_waitcnt lgkmcnt(0)
    v_readfirstlane_b32 s80, v249
    s_mov_b64 exec, -1
    s_cmp_eq_u32 s80, 3
    s_cbranch_scc0 L_g_arr
L_g_arr:
    v_mov_b32 v248, 147496
    s_mov_b32 s35, 0
L_g_wr:
    ds_read_b32 v249, v248
    s_waitcnt lgkmcnt(0)
    v_cmp_gt_u32 vcc, 4, v249
    s_cmp_eq_u64 vcc, 0
    s_cbranch_scc1 L_g_wr_ok
    s_sleep 2
    s_add_u32 s35, s35, 1
    s_cmp_lt_u32 s35, 2097152
    s_cbranch_scc1 L_g_wr
L_g_wr_ok:
    s_cmp_eq_u32 s42, 0
    s_cbranch_scc1 L_g_skip0
    s_cmp_gt_u32 s42, 0
    s_cselect_b32 s30, 1, 0
    s_sub_u32 s30, s42, s30
    s_lshl_b32 s31, 0, 1
    s_add_u32 s31, s31, s30
    s_add_u32 s31, s31, 9
    s_cmp_eq_u32 s30, 0
    s_cselect_b32 s31, 0, s31
    s_lshl_b32 s31, s31, 13
    v_add_u32 v248, s31, v229
    ds_read_b128 v[0:3], v248 offset:0
    ds_read_b128 v[4:7], v248 offset:1024
    ds_read_b128 v[8:11], v248 offset:2048
    ds_read_b128 v[12:15], v248 offset:3072
    ds_read_b128 v[16:19], v248 offset:4096
    ds_read_b128 v[20:23], v248 offset:5120
    ds_read_b128 v[24:27], v248 offset:6144
    ds_read_b128 v[28:31], v248 offset:7168
    s_waitcnt lgkmcnt(0)
    v_pk_add_f32 v[128:129], v[128:129], v[0:1]
    v_pk_add_f32 v[130:131], v[130:131], v[2:3]
    v_pk_add_f32 v[132:133], v[132:133], v[4:5]
    v_pk_add_f32 v[134:135], v[134:135], v[6:7]
    v_pk_add_f32 v[136:137], v[136:137], v[8:9]
    v_pk_add_f32 v[138:139], v[138:139], v[10:11]
    v_pk_add_f32 v[140:141], v[140:141], v[12:13]
    v_pk_add_f32 v[142:143], v[142:143], v[14:15]
    v_pk_add_f32 v[144:145], v[144:145], v[16:17]
    v_pk_add_f32 v[146:147], v[146:147], v[18:19]
    v_pk_add_f32 v[148:149], v[148:149], v[20:21]
    v_pk_add_f32 v[150:151], v[150:151], v[22:23]
    v_pk_add_f32 v[152:153], v[152:153], v[24:25]
    v_pk_add_f32 v[154:155], v[154:155], v[26:27]
    v_pk_add_f32 v[156:157], v[156:157], v[28:29]
    v_pk_add_f32 v[158:159], v[158:159], v[30:31]
L_g_skip0:
    s_cmp_eq_u32 s42, 1
    s_cbranch_scc1 L_g_skip1
    s_cmp_gt_u32 s42, 1
    s_cselect_b32 s30, 1, 0
    s_sub_u32 s30, s42, s30
    s_lshl_b32 s31, 1, 1
    s_add_u32 s31, s31, s30
    s_add_u32 s31, s31, 9
    s_cmp_eq_u32 s30, 0
    s_cselect_b32 s31, 1, s31
    s_lshl_b32 s31, s31, 13
    v_add_u32 v248, s31, v229
    ds_read_b128 v[0:3], v248 offset:0
    ds_read_b128 v[4:7], v248 offset:1024
    ds_read_b128 v[8:11], v248 offset:2048
    ds_read_b128 v[12:15], v248 offset:3072
    ds_read_b128 v[16:19], v248 offset:4096
    ds_read_b128 v[20:23], v248 offset:5120
    ds_read_b128 v[24:27], v248 offset:6144
    ds_read_b128 v[28:31], v248 offset:7168
    s_waitcnt lgkmcnt(0)
    v_pk_add_f32 v[128:129], v[128:129], v[0:1]
    v_pk_add_f32 v[130:131], v[130:131], v[2:3]
    v_pk_add_f32 v[132:133], v[132:133], v[4:5]
    v_pk_add_f32 v[134:135], v[134:135], v[6:7]
    v_pk_add_f32 v[136:137], v[136:137], v[8:9]
    v_pk_add_f32 v[138:139], v[138:139], v[10:11]
    v_pk_add_f32 v[140:141], v[140:141], v[12:13]
    v_pk_add_f32 v[142:143], v[142:143], v[14:15]
    v_pk_add_f32 v[144:145], v[144:145], v[16:17]
    v_pk_add_f32 v[146:147], v[146:147], v[18:19]
    v_pk_add_f32 v[148:149], v[148:149], v[20:21]
    v_pk_add_f32 v[150:151], v[150:151], v[22:23]
    v_pk_add_f32 v[152:153], v[152:153], v[24:25]
    v_pk_add_f32 v[154:155], v[154:155], v[26:27]
    v_pk_add_f32 v[156:157], v[156:157], v[28:29]
    v_pk_add_f32 v[158:159], v[158:159], v[30:31]
L_g_skip1:
    s_cmp_eq_u32 s42, 2
    s_cbranch_scc1 L_g_skip2
    s_cmp_gt_u32 s42, 2
    s_cselect_b32 s30, 1, 0
    s_sub_u32 s30, s42, s30
    s_lshl_b32 s31, 2, 1
    s_add_u32 s31, s31, s30
    s_add_u32 s31, s31, 9
    s_cmp_eq_u32 s30, 0
    s_cselect_b32 s31, 2, s31
    s_lshl_b32 s31, s31, 13
    v_add_u32 v248, s31, v229
    ds_read_b128 v[0:3], v248 offset:0
    ds_read_b128 v[4:7], v248 offset:1024
    ds_read_b128 v[8:11], v248 offset:2048
    ds_read_b128 v[12:15], v248 offset:3072
    ds_read_b128 v[16:19], v248 offset:4096
    ds_read_b128 v[20:23], v248 offset:5120
    ds_read_b128 v[24:27], v248 offset:6144
    ds_read_b128 v[28:31], v248 offset:7168
    s_waitcnt lgkmcnt(0)
    v_pk_add_f32 v[128:129], v[128:129], v[0:1]
    v_pk_add_f32 v[130:131], v[130:131], v[2:3]
    v_pk_add_f32 v[132:133], v[132:133], v[4:5]
    v_pk_add_f32 v[134:135], v[134:135], v[6:7]
    v_pk_add_f32 v[136:137], v[136:137], v[8:9]
    v_pk_add_f32 v[138:139], v[138:139], v[10:11]
    v_pk_add_f32 v[140:141], v[140:141], v[12:13]
    v_pk_add_f32 v[142:143], v[142:143], v[14:15]
    v_pk_add_f32 v[144:145], v[144:145], v[16:17]
    v_pk_add_f32 v[146:147], v[146:147], v[18:19]
    v_pk_add_f32 v[148:149], v[148:149], v[20:21]
    v_pk_add_f32 v[150:151], v[150:151], v[22:23]
    v_pk_add_f32 v[152:153], v[152:153], v[24:25]
    v_pk_add_f32 v[154:155], v[154:155], v[26:27]
    v_pk_add_f32 v[156:157], v[156:157], v[28:29]
    v_pk_add_f32 v[158:159], v[158:159], v[30:31]
L_g_skip2:
    s_cmp_eq_u32 s42, 3
    s_cbranch_scc1 L_g_skip3
    s_cmp_gt_u32 s42, 3
    s_cselect_b32 s30, 1, 0
    s_sub_u32 s30, s42, s30
    s_lshl_b32 s31, 3, 1
    s_add_u32 s31, s31, s30
    s_add_u32 s31, s31, 9
    s_cmp_eq_u32 s30, 0
    s_cselect_b32 s31, 3, s31
    s_lshl_b32 s31, s31, 13
    v_add_u32 v248, s31, v229
    ds_read_b128 v[0:3], v248 offset:0
    ds_read_b128 v[4:7], v248 offset:1024
    ds_read_b128 v[8:11], v248 offset:2048
    ds_read_b128 v[12:15], v248 offset:3072
    ds_read_b128 v[16:19], v248 offset:4096
    ds_read_b128 v[20:23], v248 offset:5120
    ds_read_b128 v[24:27], v248 offset:6144
    ds_read_b128 v[28:31], v248 offset:7168
    s_waitcnt lgkmcnt(0)
    v_pk_add_f32 v[128:129], v[128:129], v[0:1]
    v_pk_add_f32 v[130:131], v[130:131], v[2:3]
    v_pk_add_f32 v[132:133], v[132:133], v[4:5]
    v_pk_add_f32 v[134:135], v[134:135], v[6:7]
    v_pk_add_f32 v[136:137], v[136:137], v[8:9]
    v_pk_add_f32 v[138:139], v[138:139], v[10:11]
    v_pk_add_f32 v[140:141], v[140:141], v[12:13]
    v_pk_add_f32 v[142:143], v[142:143], v[14:15]
    v_pk_add_f32 v[144:145], v[144:145], v[16:17]
    v_pk_add_f32 v[146:147], v[146:147], v[18:19]
    v_pk_add_f32 v[148:149], v[148:149], v[20:21]
    v_pk_add_f32 v[150:151], v[150:151], v[22:23]
    v_pk_add_f32 v[152:153], v[152:153], v[24:25]
    v_pk_add_f32 v[154:155], v[154:155], v[26:27]
    v_pk_add_f32 v[156:157], v[156:157], v[28:29]
    v_pk_add_f32 v[158:159], v[158:159], v[30:31]
L_g_skip3:
    s_barrier
    v_and_b32 v248, 15, v228
    s_lshl_b32 s29, s40, 7
    s_lshl_b32 s30, s42, 5
    s_add_u32 s29, s29, s30
    v_add_u32 v248, s29, v248
    v_lshlrev_b32 v248, 11, v248
    v_lshlrev_b32 v249, 1, v228
    v_and_b32 v249, 32, v249
    v_add_u32 v248, v248, v249
    v_lshrrev_b32 v249, 1, v228
    v_and_b32 v249, 16, v249
    v_add_u32 v248, v248, v249
    s_lshl_b32 s29, s41, 7
    s_add_u32 s30, s29, 32768
    s_waitcnt vmcnt(0)
    s_barrier
    ds_read_b128 v[0:3], v252 offset:0
    ds_read_b128 v[4:7], v252 offset:1024
    ds_read_b128 v[8:11], v252 offset:2048
    ds_read_b128 v[12:15], v252 offset:3072
    ds_read_b128 v[16:19], v252 offset:4096
    ds_read_b128 v[20:23], v252 offset:5120
    ds_read_b128 v[24:27], v252 offset:6144
    ds_read_b128 v[28:31], v252 offset:7168
    ds_read_b128 v[32:35], v252 offset:32768
    ds_read_b128 v[36:39], v252 offset:33792
    ds_read_b128 v[40:43], v252 offset:34816
    ds_read_b128 v[44:47], v252 offset:35840
    ds_read_b128 v[48:51], v252 offset:36864
    ds_read_b128 v[52:55], v252 offset:37888
    ds_read_b128 v[56:59], v252 offset:38912
    ds_read_b128 v[60:63], v252 offset:39936
    s_waitcnt lgkmcnt(0)
    v_pk_add_f32 v[32:33], v[32:33], v[0:1]
    v_pk_add_f32 v[34:35], v[34:35], v[2:3]
    v_pk_add_f32 v[36:37], v[36:37], v[4:5]
    v_pk_add_f32 v[38:39], v[38:39], v[6:7]
    v_pk_add_f32 v[40:41], v[40:41], v[8:9]
    v_pk_add_f32 v[42:43], v[42:43], v[10:11]
    v_pk_add_f32 v[44:45], v[44:45], v[12:13]
    v_pk_add_f32 v[46:47], v[46:47], v[14:15]
    v_pk_add_f32 v[48:49], v[48:49], v[16:17]
    v_pk_add_f32 v[50:51], v[50:51], v[18:19]
    v_pk_add_f32 v[52:53], v[52:53], v[20:21]
    v_pk_add_f32 v[54:55], v[54:55], v[22:23]
    v_pk_add_f32 v[56:57], v[56:57], v[24:25]
    v_pk_add_f32 v[58:59], v[58:59], v[26:27]
    v_pk_add_f32 v[60:61], v[60:61], v[28:29]
    v_pk_add_f32 v[62:63], v[62:63], v[30:31]
    ds_read_b128 v[64:67], v253 offset:0
    ds_read_b128 v[68:71], v253 offset:1024
    ds_read_b128 v[72:75], v253 offset:2048
    ds_read_b128 v[76:79], v253 offset:3072
    ds_read_b128 v[80:83], v253 offset:4096
    ds_read_b128 v[84:87], v253 offset:5120
    ds_read_b128 v[88:91], v253 offset:6144
    ds_read_b128 v[92:95], v253 offset:7168
    ds_read_b128 v[96:99], v253 offset:32768
    ds_read_b128 v[100:103], v253 offset:33792
    ds_read_b128 v[104:107], v253 offset:34816
    ds_read_b128 v[108:111], v253 offset:35840
    ds_read_b128 v[112:115], v253 offset:36864
    ds_read_b128 v[116:119], v253 offset:37888
    ds_read_b128 v[120:123], v253 offset:38912
    ds_read_b128 v[124:127], v253 offset:39936
    s_waitcnt lgkmcnt(0)
    v_pk_add_f32 v[96:97], v[96:97], v[64:65]
    v_pk_add_f32 v[98:99], v[98:99], v[66:67]
    v_pk_add_f32 v[100:101], v[100:101], v[68:69]
    v_pk_add_f32 v[102:103], v[102:103], v[70:71]
    v_pk_add_f32 v[104:105], v[104:105], v[72:73]
    v_pk_add_f32 v[106:107], v[106:107], v[74:75]
    v_pk_add_f32 v[108:109], v[108:109], v[76:77]
    v_pk_add_f32 v[110:111], v[110:111], v[78:79]
    v_pk_add_f32 v[112:113], v[112:113], v[80:81]
    v_pk_add_f32 v[114:115], v[114:115], v[82:83]
    v_pk_add_f32 v[116:117], v[116:117], v[84:85]
    v_pk_add_f32 v[118:119], v[118:119], v[86:87]
    v_pk_add_f32 v[120:121], v[120:121], v[88:89]
    v_pk_add_f32 v[122:123], v[122:123], v[90:91]
    v_pk_add_f32 v[124:125], v[124:125], v[92:93]
    v_pk_add_f32 v[126:127], v[126:127], v[94:95]
    v_pk_add_f32 v[32:33], v[32:33], v[96:97]
    v_fmac_f32 v128, v32, v240
    v_fmac_f32 v129, v33, v240
    v_pk_add_f32 v[34:35], v[34:35], v[98:99]
    v_fmac_f32 v130, v34, v240
    v_fmac_f32 v131, v35, v240
    v_pk_add_f32 v[36:37], v[36:37], v[100:101]
    v_fmac_f32 v132, v36, v240
    v_fmac_f32 v133, v37, v240
    v_pk_add_f32 v[38:39], v[38:39], v[102:103]
    v_fmac_f32 v134, v38, v240
    v_fmac_f32 v135, v39, v240
    v_pk_add_f32 v[40:41], v[40:41], v[104:105]
    v_fmac_f32 v136, v40, v240
    v_fmac_f32 v137, v41, v240
    v_pk_add_f32 v[42:43], v[42:43], v[106:107]
    v_fmac_f32 v138, v42, v240
    v_fmac_f32 v139, v43, v240
    v_pk_add_f32 v[44:45], v[44:45], v[108:109]
    v_fmac_f32 v140, v44, v240
    v_fmac_f32 v141, v45, v240
    v_pk_add_f32 v[46:47], v[46:47], v[110:111]
    v_fmac_f32 v142, v46, v240
    v_fmac_f32 v143, v47, v240
    v_pk_add_f32 v[48:49], v[48:49], v[112:113]
    v_fmac_f32 v144, v48, v241
    v_fmac_f32 v145, v49, v241
    v_pk_add_f32 v[50:51], v[50:51], v[114:115]
    v_fmac_f32 v146, v50, v241
    v_fmac_f32 v147, v51, v241
    v_pk_add_f32 v[52:53], v[52:53], v[116:117]
    v_fmac_f32 v148, v52, v241
    v_fmac_f32 v149, v53, v241
    v_pk_add_f32 v[54:55], v[54:55], v[118:119]
    v_fmac_f32 v150, v54, v241
    v_fmac_f32 v151, v55, v241
    v_pk_add_f32 v[56:57], v[56:57], v[120:121]
    v_fmac_f32 v152, v56, v241
    v_fmac_f32 v153, v57, v241
    v_pk_add_f32 v[58:59], v[58:59], v[122:123]
    v_fmac_f32 v154, v58, v241
    v_fmac_f32 v155, v59, v241
    v_pk_add_f32 v[60:61], v[60:61], v[124:125]
    v_fmac_f32 v156, v60, v241
    v_fmac_f32 v157, v61, v241
    v_pk_add_f32 v[62:63], v[62:63], v[126:127]
    v_fmac_f32 v158, v62, v241
    v_fmac_f32 v159, v63, v241
    v_cvt_pk_bf16_f32 v160, v128, v129
    v_cvt_pk_bf16_f32 v161, v130, v131
    v_cvt_pk_bf16_f32 v162, v132, v133
    v_cvt_pk_bf16_f32 v163, v134, v135
    v_cvt_pk_bf16_f32 v164, v136, v137
    v_cvt_pk_bf16_f32 v165, v138, v139
    v_cvt_pk_bf16_f32 v166, v140, v141
    v_cvt_pk_bf16_f32 v167, v142, v143
    v_cvt_pk_bf16_f32 v168, v144, v145
    v_cvt_pk_bf16_f32 v169, v146, v147
    v_cvt_pk_bf16_f32 v170, v148, v149
    v_cvt_pk_bf16_f32 v171, v150, v151
    v_cvt_pk_bf16_f32 v172, v152, v153
    v_cvt_pk_bf16_f32 v173, v154, v155
    v_cvt_pk_bf16_f32 v174, v156, v157
    v_cvt_pk_bf16_f32 v175, v158, v159
    s_nop 1
    v_permlane16_swap_b32 v160, v162
    v_permlane16_swap_b32 v161, v163
    v_permlane16_swap_b32 v164, v166
    v_permlane16_swap_b32 v165, v167
    v_permlane16_swap_b32 v168, v170
    v_permlane16_swap_b32 v169, v171
    v_permlane16_swap_b32 v172, v174
    v_permlane16_swap_b32 v173, v175
    buffer_store_dwordx4 v[160:163], v248, s[16:19], s29 offen offset:0
    buffer_store_dwordx4 v[164:167], v248, s[16:19], s29 offen offset:64
    buffer_store_dwordx4 v[168:171], v248, s[16:19], s30 offen offset:0
    buffer_store_dwordx4 v[172:175], v248, s[16:19], s30 offen offset:64
L_end:
    s_endpgm
L_code_end:
.section .rodata,"a"
.p2align 6
.amdhsa_kernel gated_mix__softmax_full_mha__swiglu_ffn__prompt_kernel
  .amdhsa_next_free_vgpr 256
  .amdhsa_next_free_sgpr 102
  .amdhsa_accum_offset 256
  .amdhsa_group_segment_fixed_size 0
  .amdhsa_kernarg_size 88
  .amdhsa_user_sgpr_count 2
  .amdhsa_user_sgpr_kernarg_segment_ptr 1
  .amdhsa_system_sgpr_workgroup_id_x 1
.end_amdhsa_kernel
```
